```python
import torch

def _softmax(x, axis=-1):
    return torch.softmax(x, dim=axis)
def _gelu(x):
    return torch.nn.functional.gelu(x, approximate="tanh")
def _silu(x):
    return torch.nn.functional.silu(x)
def _sigmoid(x):
    return torch.sigmoid(x)
def _layernorm(x, axis=-1, eps=1e-5):
    m = x.mean(dim=axis, keepdim=True)
    v = x.var(dim=axis, keepdim=True, unbiased=False)
    return (x - m) / torch.sqrt(v + eps)
def _scatter_add(tgt, idx, src, axis=0):
    return tgt.clone().index_add_(axis, idx, src)
def _segment_sum(src, seg, n):
    out = torch.zeros((n,) + src.shape[1:], dtype=src.dtype)
    return out.index_add_(0, seg, src)
def _pad(x, pw):
    flat = tuple(v for pair in reversed(pw) for v in pair)
    return torch.nn.functional.pad(x, flat)

kernel_name = 'gated_mix__sliding_local_dilated__dense_activation_squared_relu__prompt'

def setup_inputs():

    _w = (lambda a: (lambda t: t.to(torch.bfloat16) if t.is_floating_point() else t)(torch.as_tensor(a)))
    def _A_setup():
        B, S, D = 1, 2048, 640
        return {
            "x": _w((lambda *s: torch.randn(*s, dtype=torch.bfloat16) * 0.05)(B, S, D)),
            "wqkv": _w((lambda *s: torch.randn(*s, dtype=torch.bfloat16) * 0.8)(D, 3 * D)),
            "wo": _w((lambda *s: torch.randn(*s, dtype=torch.bfloat16) * 0.05)(D, D)),
        }
    _A_in = _A_setup()

    def _B_setup():
        B, S, D, F = 1, 2048, 640, 1728
        return {
            "x": _w((lambda *s: torch.randn(*s, dtype=torch.bfloat16) * 0.05)(B, S, D)),
            "w1": _w((lambda *s: torch.randn(*s, dtype=torch.bfloat16) * 0.2)(D, F)),
            "b1": _w((lambda *s: torch.randn(*s, dtype=torch.bfloat16) * 0.2)(F)),
            "w2": _w((lambda *s: torch.randn(*s, dtype=torch.bfloat16) * 0.2)(F, D)),
            "b2": _w((lambda *s: torch.randn(*s, dtype=torch.bfloat16) * 0.2)(D)),
        }
    _B_in = _B_setup()

    return {
        "A_x": _A_in["x"],
        "A_wqkv": _A_in["wqkv"],
        "A_wo": _A_in["wo"],
        "B_x": _B_in["x"],
        "B_w1": _B_in["w1"],
        "B_b1": _B_in["b1"],
        "B_w2": _B_in["w2"],
        "B_b2": _B_in["b2"],
        "gate_w": _w((lambda *s: torch.randn(*s, dtype=torch.bfloat16) * 0.05)(640) * 16.0),
    }

def reference(A_x, A_wqkv, A_wo, B_x, B_w1, B_b1, B_w2, B_b2, gate_w):
    def _A_ref(x, wqkv, wo):
        B, S, D = x.shape
        H = 32; Dh = D // H
        W, dil = 8, 2
        qkv = (lambda x, *d: x.permute(*d))((x @ wqkv).reshape(B, S, 3, H, Dh), 2, 0, 3, 1, 4)
        q, k, v = qkv[0], qkv[1], qkv[2]
        scale = Dh ** -0.5
        pos = torch.arange(S)
        off = torch.arange(W) * dil
        idx = pos[:, None] - off[None, :]
        mask = idx >= 0
        idx_c = torch.where(mask, idx, 0).reshape(-1)
        kg = k[:, :, idx_c, :].reshape(B, H, S, W, Dh)
        vg = v[:, :, idx_c, :].reshape(B, H, S, W, Dh)
        logits = torch.einsum("bhsd,bhswd->bhsw", q, kg) * scale
        logits = torch.where(mask[None, None, :, :], logits, -1e9)
        attn = _softmax(logits, axis=-1)
        o = torch.einsum("bhsw,bhswd->bhsd", attn, vg)
        return (lambda x, *d: x.permute(*d))(o, 0, 2, 1, 3).reshape(B, S, D) @ wo

    def _B_ref(x, w1, b1, w2, b2):
        h = torch.einsum("bsd,df->bsf", x, w1) + b1
        zero = torch.zeros_like(h)
        r = torch.where(h > zero, h, zero)
        h = r * r
        out = torch.einsum("bsf,fd->bsd", h, w2) + b2
        return out

    x = A_x
    g = _sigmoid((x * gate_w).sum(-1, keepdims=True))
    a = _A_ref(x, A_wqkv, A_wo)
    b = _B_ref(x, B_w1, B_b1, B_w2, B_b2)
    return g * a + (1 - g) * b
```

```asm
; @launch grid=(256,1,1) block=(512,1,1) lds=163840
.amdgcn_target "amdgcn-amd-amdhsa--gfx950"
.text
.globl gated_mix__sliding_local_dilated__dense_activation_squared_relu__prompt_kernel
.p2align 8
.type gated_mix__sliding_local_dilated__dense_activation_squared_relu__prompt_kernel,@function
gated_mix__sliding_local_dilated__dense_activation_squared_relu__prompt_kernel:
    s_cmp_ge_u32 s2, 256
    s_cbranch_scc1 L_end
    s_load_dwordx16 s[8:23], s[0:1], 0
    s_load_dwordx8 s[24:31], s[0:1], 64
    v_and_b32 v1, 63, v0
    v_lshrrev_b32 v2, 6, v0
    s_nop 0
    v_readfirstlane_b32 s32, v2
    s_nop 3
    s_cmp_eq_u32 s32, 4
    s_cbranch_scc1 L_ldx
    s_cmp_eq_u32 s32, 5
    s_cbranch_scc1 L_ldw0
    s_cmp_eq_u32 s32, 6
    s_cbranch_scc1 L_ldw1
    s_cmp_eq_u32 s32, 7
    s_cbranch_scc1 L_helper
    s_and_b32 s100, s2, 1
    s_bfe_u32 s101, s2, 0x20001
    s_lshr_b32 s85, s2, 3
    s_cmp_lt_u32 s85, 18
    s_cselect_b32 s33, 1, 0
    s_cbranch_scc0 L_role_bc
    s_mul_i32 s34, s100, 9
    s_lshr_b32 s58, s85, 1
    s_add_u32 s34, s34, s58
    s_lshl_b32 s35, s101, 1
    s_and_b32 s58, s85, 1
    s_add_u32 s35, s35, s58
    s_branch L_role_donec
L_role_bc:
    s_mul_i32 s58, s101, 14
    s_add_u32 s58, s58, s85
    s_sub_u32 s58, s58, 18
    s_lshr_b32 s35, s58, 3
    s_and_b32 s58, s58, 7
    s_lshl_b32 s34, s100, 3
    s_add_u32 s34, s34, s58
L_role_donec:
    s_mul_i32 s58, s100, 9
    s_lshl_b32 s59, s100, 3
    s_cmp_eq_u32 s33, 1
    s_cselect_b32 s58, s58, s59
    s_sub_u32 s3, s34, s58
    s_and_b32 s58, s35, 1
    s_mul_i32 s58, s58, 5
    s_add_u32 s3, s3, s58
    s_cmp_eq_u32 s33, 1
    s_cselect_b32 s58, 0, 2
    s_add_u32 s3, s3, s58
    s_mul_i32 s58, s3, 205
    s_lshr_b32 s58, s58, 11
    s_mul_i32 s58, s58, 10
    s_sub_u32 s3, s3, s58
    s_and_b32 s56, s2, 7
    s_lshr_b32 s57, s2, 3
    s_lshl_b32 s78, s56, 2
    s_lshr_b32 s58, s57, 3
    s_add_u32 s78, s78, s58
    s_and_b32 s79, s57, 7
    s_and_b32 s83, s35, 1
    s_mul_i32 s76, s34, 114
    s_sub_u32 s76, s76, 14
    s_cmp_eq_u32 s33, 1
    s_mov_b32 s77, 3456
    s_cselect_b32 s77, 3840, s77
    s_lshl_b32 s58, s34, 3
    s_add_u32 s58, s58, s35
    s_mul_i32 s59, s34, 7
    s_add_u32 s59, s59, s35
    s_add_u32 s59, s59, 144
    s_cmp_eq_u32 s33, 1
    s_cselect_b32 s84, s58, s59
    s_waitcnt lgkmcnt(0)
    s_mov_b32 s36, s8
    s_and_b32 s37, s9, 0xffff
    s_mov_b32 s38, 2621440
    s_mov_b32 s39, 0x20000
    s_cmp_eq_u32 s33, 1
    s_cselect_b32 s40, s10, s16
    s_cselect_b32 s56, s11, s17
    s_mov_b32 s42, 2211840
    s_cselect_b32 s42, 2457600, s42
    s_and_b32 s41, s56, 0xffff
    s_mov_b32 s43, 0x20000
    s_mov_b32 s44, s30
    s_and_b32 s45, s31, 0xffff
    s_mov_b32 s46, 14680064
    s_mov_b32 s47, 0x20000
    s_mov_b32 s96, s28
    s_and_b32 s97, s29, 0xffff
    s_mov_b32 s98, 256
    s_mov_b32 s99, 0x20000
    s_lshr_b32 s74, s32, 1
    s_and_b32 s75, s32, 1
    s_cmp_eq_u32 s2, 0
    s_cbranch_scc0 L_noclear
    s_cmp_eq_u32 s32, 0
    s_cbranch_scc0 L_noclear
    v_lshlrev_b32 v8, 6, v1
    v_mov_b32 v9, 0
    s_mov_b32 s56, 13697024
    buffer_store_dword v9, v8, s[44:47], s56 offen sc1
    s_mov_b32 s56, 13701120
    buffer_store_dword v9, v8, s[44:47], s56 offen sc1
    s_mov_b32 s56, 13705216
    buffer_store_dword v9, v8, s[44:47], s56 offen sc1
    s_mov_b32 s56, 13709312
    buffer_store_dword v9, v8, s[44:47], s56 offen sc1
    s_mov_b32 s56, 13713408
    buffer_store_dword v9, v8, s[44:47], s56 offen sc1
    s_mov_b32 s56, 13717504
    buffer_store_dword v9, v8, s[44:47], s56 offen sc1
    s_mov_b32 s56, 13721600
    buffer_store_dword v9, v8, s[44:47], s56 offen sc1
    s_mov_b32 s56, 13725696
    buffer_store_dword v9, v8, s[44:47], s56 offen sc1
    s_waitcnt vmcnt(0)
    v_mov_b32 v9, 1
    v_mov_b32 v8, 0
    s_mov_b64 s[88:89], exec
    s_mov_b64 exec, 1
    buffer_store_dword v9, v8, s[96:99], 0 offen sc1
    s_mov_b64 exec, s[88:89]
L_noclear:
    s_mov_b32 s48, s18
    s_and_b32 s49, s19, 0xffff
    s_cmp_eq_u32 s33, 1
    s_cselect_b32 s50, 0, 3456
    s_mov_b32 s51, 0x20000
    v_lshrrev_b32 v7, 4, v1
    v_lshlrev_b32 v232, 3, v7
    s_lshl_b32 s56, s35, 9
    s_lshl_b32 s57, s75, 8
    s_add_u32 s56, s56, s57
    v_add_u32 v232, s56, v232
    buffer_load_dwordx2 v[136:137], v232, s[48:51], 0 offen offset:0
    buffer_load_dwordx2 v[138:139], v232, s[48:51], 0 offen offset:32
    buffer_load_dwordx2 v[140:141], v232, s[48:51], 0 offen offset:64
    buffer_load_dwordx2 v[142:143], v232, s[48:51], 0 offen offset:96
    buffer_load_dwordx2 v[144:145], v232, s[48:51], 0 offen offset:128
    buffer_load_dwordx2 v[146:147], v232, s[48:51], 0 offen offset:160
    buffer_load_dwordx2 v[148:149], v232, s[48:51], 0 offen offset:192
    buffer_load_dwordx2 v[150:151], v232, s[48:51], 0 offen offset:224
    v_and_b32 v233, 15, v1
    v_bfe_u32 v234, v233, 1, 3
    v_xor_b32 v234, v7, v234
    v_lshlrev_b32 v234, 4, v234
    v_lshl_add_u32 v2, v233, 7, v234
    s_lshl_b32 s56, s74, 13
    v_add_u32 v2, s56, v2
    v_xor_b32 v5, 64, v2
    v_lshrrev_b32 v233, 2, v1
    v_and_b32 v233, 3, v233
    v_lshl_add_u32 v233, v7, 3, v233
    v_and_b32 v234, 3, v1
    v_lshlrev_b32 v234, 3, v234
    v_lshl_add_u32 v235, v233, 6, v234
    s_lshl_b32 s56, s75, 13
    s_add_u32 s56, s56, 65536
    v_add_u32 v235, s56, v235
    v_and_b32 v236, 1, v7
    v_lshlrev_b32 v236, 5, v236
    v_add_u32 v3, v235, v236
    v_xor_b32 v236, 32, v236
    v_add_u32 v4, v235, v236
    s_cmp_lt_u32 s32, 2
    s_cbranch_scc1 L_p3o_1
    s_add_u32 s56, s32, 2
    s_sub_u32 s57, s32, 4
    s_cmp_ge_u32 s32, 4
    s_cselect_b32 s56, s57, s56
    s_mul_i32 s58, s56, 9
    s_mul_i32 s80, s78, 54
    s_add_u32 s80, s80, s58
    s_lshl_b32 s80, s80, 12
    s_add_u32 s59, s58, 20
    s_mov_b32 s64, 9
    s_mov_b32 s62, 2147483648
    s_branch L_p3d_2
L_p3o_1:
    s_mul_i32 s59, s32, 10
    s_mul_i32 s80, s78, 20
    s_add_u32 s80, s80, s59
    s_lshl_b32 s80, s80, 12
    s_add_u32 s80, s80, 7340032
    s_mov_b32 s64, 10
    s_mov_b32 s62, 0
L_p3d_2:
    s_mul_i32 s81, s79, 74
    s_add_u32 s81, s81, s59
    s_mul_i32 s81, s81, 5120
    s_add_u32 s81, s81, 10485760
    s_mov_b32 s82, s79
    s_sub_u32 s60, s82, s64
    s_cmp_ge_u32 s82, s64
    s_cselect_b32 s82, s60, s82
    v_lshrrev_b32 v6, 1, v1
    v_add_u32 v6, s59, v6
    v_mul_u32_u24 v6, 10, v6
    s_mul_i32 s60, s79, 5
    s_lshr_b32 s60, s60, 2
    v_and_b32 v7, 1, v1
    v_add_u32 v6, v6, v7
    v_add_u32 v6, s60, v6
    v_mul_u32_u24 v7, 16384, v6
    v_lshrrev_b32 v7, 16, v7
    v_cmp_gt_u32 vcc, 448, v6
    v_subrev_u32 v6, 448, v6
    v_and_b32 v6, 0x3ff, v6
    v_mul_u32_u24 v6, 21846, v6
    v_lshrrev_b32 v6, 16, v6
    v_add_u32 v6, 112, v6
    v_cndmask_b32 v6, v6, v7, vcc
    v_lshlrev_b32 v6, 6, v6
    s_lshl_b32 s60, s64, 1
    v_cmp_gt_u32 vcc, s60, v1
    v_mov_b32 v7, 2147483648
    s_nop 0
    v_cndmask_b32 v232, v7, v6, vcc
    s_and_b32 s56, s32, 3
    s_lshr_b32 s57, s32, 2
    s_mul_i32 s58, s57, 31232
    s_mul_i32 s59, s56, 40
    s_add_u32 s58, s58, s59
    s_add_u32 s58, s58, 28864
    v_mul_u32_u24 v240, 488, v1
    v_add_u32 v240, s58, v240
    v_and_b32 v60, 48, v1
    v_and_b32 v61, 3, v1
    v_lshl_add_u32 v60, v61, 2, v60
    v_bfe_u32 v61, v1, 2, 2
    v_add_u32 v60, v60, v61
    v_mul_u32_u24 v241, 488, v60
    v_add_u32 v241, s58, v241
    s_mul_i32 s58, s57, 11264
    s_add_u32 s58, s58, s59
    s_add_u32 s58, s58, 133120
    v_mul_u32_u24 v242, 176, v1
    v_add_u32 v242, s58, v242
    s_add_u32 s56, s32, 0
    s_lshr_b32 s57, s56, 1
    s_and_b32 s56, s56, 1
    s_lshl_b32 s58, s56, 6
    v_add_u32 v60, s58, v1
    v_add_u32 v61, 14, v60
    v_and_b32 v62, 1, v61
    v_lshrrev_b32 v63, 1, v61
    v_lshl_add_u32 v62, v62, 6, v63
    v_min_u32 v62, 127, v62
    v_mul_u32_u24 v62, 176, v62
    s_lshl_b32 s59, s57, 4
    s_add_u32 s59, s59, 133120
    v_add_u32 v243, s59, v62
    s_add_u32 s59, s76, 14
    v_add_u32 v63, s59, v60
    s_mul_i32 s60, s35, 10
    s_add_u32 s60, s60, s57
    s_lshr_b32 s61, s60, 2
    s_and_b32 s60, s60, 3
    s_lshl_b32 s61, s61, 12
    s_lshl_b32 s60, s60, 8
    s_add_u32 s61, s61, s60
    s_add_u32 s71, s61, 7340032
    v_lshrrev_b32 v64, 6, v63
    v_mul_u32_u24 v64, 81920, v64
    v_bfe_u32 v65, v63, 4, 2
    v_lshl_add_u32 v64, v65, 10, v64
    v_and_b32 v65, 15, v63
    v_lshl_add_u32 v64, v65, 4, v64
    v_cmp_gt_u32 vcc, 114, v60
    s_nop 3
    s_mov_b64 s[88:89], vcc
    v_cmp_gt_u32 vcc, 2048, v63
    s_nop 3
    s_and_b64 vcc, vcc, s[88:89]
    v_mov_b32 v65, 2147483648
    s_nop 1
    v_cndmask_b32 v244, v65, v64, vcc
    s_add_u32 s56, s32, 8
    s_lshr_b32 s57, s56, 1
    s_and_b32 s56, s56, 1
    s_lshl_b32 s58, s56, 6
    v_add_u32 v60, s58, v1
    v_add_u32 v61, 14, v60
    v_and_b32 v62, 1, v61
    v_lshrrev_b32 v63, 1, v61
    v_lshl_add_u32 v62, v62, 6, v63
    v_min_u32 v62, 127, v62
    v_mul_u32_u24 v62, 176, v62
    s_lshl_b32 s59, s57, 4
    s_add_u32 s59, s59, 133120
    v_add_u32 v245, s59, v62
    s_add_u32 s59, s76, 14
    v_add_u32 v63, s59, v60
    s_mul_i32 s60, s35, 10
    s_add_u32 s60, s60, s57
    s_lshr_b32 s61, s60, 2
    s_and_b32 s60, s60, 3
    s_lshl_b32 s61, s61, 12
    s_lshl_b32 s60, s60, 8
    s_add_u32 s61, s61, s60
    s_add_u32 s72, s61, 7340032
    v_lshrrev_b32 v64, 6, v63
    v_mul_u32_u24 v64, 81920, v64
    v_bfe_u32 v65, v63, 4, 2
    v_lshl_add_u32 v64, v65, 10, v64
    v_and_b32 v65, 15, v63
    v_lshl_add_u32 v64, v65, 4, v64
    v_cmp_gt_u32 vcc, 114, v60
    s_nop 3
    s_mov_b64 s[88:89], vcc
    v_cmp_gt_u32 vcc, 2048, v63
    s_nop 3
    s_and_b64 vcc, vcc, s[88:89]
    v_mov_b32 v65, 2147483648
    s_nop 1
    v_cndmask_b32 v246, v65, v64, vcc
    s_add_u32 s56, s32, 16
    s_lshr_b32 s57, s56, 1
    s_and_b32 s56, s56, 1
    s_lshl_b32 s58, s56, 6
    v_add_u32 v60, s58, v1
    v_add_u32 v61, 14, v60
    v_and_b32 v62, 1, v61
    v_lshrrev_b32 v63, 1, v61
    v_lshl_add_u32 v62, v62, 6, v63
    v_min_u32 v62, 127, v62
    v_mul_u32_u24 v62, 176, v62
    s_lshl_b32 s59, s57, 4
    s_add_u32 s59, s59, 133120
    v_add_u32 v247, s59, v62
    s_add_u32 s59, s76, 14
    v_add_u32 v63, s59, v60
    s_mul_i32 s60, s35, 10
    s_add_u32 s60, s60, s57
    s_lshr_b32 s61, s60, 2
    s_and_b32 s60, s60, 3
    s_lshl_b32 s61, s61, 12
    s_lshl_b32 s60, s60, 8
    s_add_u32 s61, s61, s60
    s_add_u32 s73, s61, 7340032
    v_lshrrev_b32 v64, 6, v63
    v_mul_u32_u24 v64, 81920, v64
    v_bfe_u32 v65, v63, 4, 2
    v_lshl_add_u32 v64, v65, 10, v64
    v_and_b32 v65, 15, v63
    v_lshl_add_u32 v64, v65, 4, v64
    v_cmp_gt_u32 vcc, 114, v60
    s_nop 3
    s_mov_b64 s[88:89], vcc
    v_cmp_gt_u32 vcc, 2048, v63
    s_nop 3
    s_and_b64 vcc, vcc, s[88:89]
    v_mov_b32 v65, 2147483648
    s_nop 1
    v_cndmask_b32 v248, v65, v64, vcc
    v_and_b32 v233, 15, v1
    v_lshrrev_b32 v7, 4, v1
    s_lshl_b32 s56, s74, 6
    v_add_u32 v233, s56, v233
    v_mul_u32_u24 v234, 488, v233
    v_lshl_add_u32 v234, v7, 3, v234
    v_add_u32 v234, 32768, v234
    s_lshl_b32 s56, s83, 5
    v_add_u32 v235, s56, v234
    s_lshl_b32 s56, s83, 7
    v_subrev_u32 v236, s56, v234
    s_waitcnt vmcnt(0)
    v_lshlrev_b32 v8, 16, v136
    v_and_b32 v9, 0xffff0000, v136
    v_lshlrev_b32 v10, 16, v137
    v_and_b32 v11, 0xffff0000, v137
    v_mov_b32 v12, v8
    v_mov_b32 v13, v9
    v_mov_b32 v14, v10
    v_mov_b32 v15, v11
    v_mov_b32 v16, v8
    v_mov_b32 v17, v9
    v_mov_b32 v18, v10
    v_mov_b32 v19, v11
    v_mov_b32 v20, v8
    v_mov_b32 v21, v9
    v_mov_b32 v22, v10
    v_mov_b32 v23, v11
    v_lshlrev_b32 v24, 16, v138
    v_and_b32 v25, 0xffff0000, v138
    v_lshlrev_b32 v26, 16, v139
    v_and_b32 v27, 0xffff0000, v139
    v_mov_b32 v28, v24
    v_mov_b32 v29, v25
    v_mov_b32 v30, v26
    v_mov_b32 v31, v27
    v_mov_b32 v32, v24
    v_mov_b32 v33, v25
    v_mov_b32 v34, v26
    v_mov_b32 v35, v27
    v_mov_b32 v36, v24
    v_mov_b32 v37, v25
    v_mov_b32 v38, v26
    v_mov_b32 v39, v27
    v_lshlrev_b32 v40, 16, v140
    v_and_b32 v41, 0xffff0000, v140
    v_lshlrev_b32 v42, 16, v141
    v_and_b32 v43, 0xffff0000, v141
    v_mov_b32 v44, v40
    v_mov_b32 v45, v41
    v_mov_b32 v46, v42
    v_mov_b32 v47, v43
    v_mov_b32 v48, v40
    v_mov_b32 v49, v41
    v_mov_b32 v50, v42
    v_mov_b32 v51, v43
    v_mov_b32 v52, v40
    v_mov_b32 v53, v41
    v_mov_b32 v54, v42
    v_mov_b32 v55, v43
    v_lshlrev_b32 v56, 16, v142
    v_and_b32 v57, 0xffff0000, v142
    v_lshlrev_b32 v58, 16, v143
    v_and_b32 v59, 0xffff0000, v143
    v_mov_b32 v60, v56
    v_mov_b32 v61, v57
    v_mov_b32 v62, v58
    v_mov_b32 v63, v59
    v_mov_b32 v64, v56
    v_mov_b32 v65, v57
    v_mov_b32 v66, v58
    v_mov_b32 v67, v59
    v_mov_b32 v68, v56
    v_mov_b32 v69, v57
    v_mov_b32 v70, v58
    v_mov_b32 v71, v59
    v_lshlrev_b32 v72, 16, v144
    v_and_b32 v73, 0xffff0000, v144
    v_lshlrev_b32 v74, 16, v145
    v_and_b32 v75, 0xffff0000, v145
    v_mov_b32 v76, v72
    v_mov_b32 v77, v73
    v_mov_b32 v78, v74
    v_mov_b32 v79, v75
    v_mov_b32 v80, v72
    v_mov_b32 v81, v73
    v_mov_b32 v82, v74
    v_mov_b32 v83, v75
    v_mov_b32 v84, v72
    v_mov_b32 v85, v73
    v_mov_b32 v86, v74
    v_mov_b32 v87, v75
    v_lshlrev_b32 v88, 16, v146
    v_and_b32 v89, 0xffff0000, v146
    v_lshlrev_b32 v90, 16, v147
    v_and_b32 v91, 0xffff0000, v147
    v_mov_b32 v92, v88
    v_mov_b32 v93, v89
    v_mov_b32 v94, v90
    v_mov_b32 v95, v91
    v_mov_b32 v96, v88
    v_mov_b32 v97, v89
    v_mov_b32 v98, v90
    v_mov_b32 v99, v91
    v_mov_b32 v100, v88
    v_mov_b32 v101, v89
    v_mov_b32 v102, v90
    v_mov_b32 v103, v91
    v_lshlrev_b32 v104, 16, v148
    v_and_b32 v105, 0xffff0000, v148
    v_lshlrev_b32 v106, 16, v149
    v_and_b32 v107, 0xffff0000, v149
    v_mov_b32 v108, v104
    v_mov_b32 v109, v105
    v_mov_b32 v110, v106
    v_mov_b32 v111, v107
    v_mov_b32 v112, v104
    v_mov_b32 v113, v105
    v_mov_b32 v114, v106
    v_mov_b32 v115, v107
    v_mov_b32 v116, v104
    v_mov_b32 v117, v105
    v_mov_b32 v118, v106
    v_mov_b32 v119, v107
    v_lshlrev_b32 v120, 16, v150
    v_and_b32 v121, 0xffff0000, v150
    v_lshlrev_b32 v122, 16, v151
    v_and_b32 v123, 0xffff0000, v151
    v_mov_b32 v124, v120
    v_mov_b32 v125, v121
    v_mov_b32 v126, v122
    v_mov_b32 v127, v123
    v_mov_b32 v128, v120
    v_mov_b32 v129, v121
    v_mov_b32 v130, v122
    v_mov_b32 v131, v123
    v_mov_b32 v132, v120
    v_mov_b32 v133, v121
    v_mov_b32 v134, v122
    v_mov_b32 v135, v123
    s_barrier
    ds_read_b128 v[136:139], v2 offset:0
    ds_read_b128 v[140:143], v2 offset:2048
    ds_read_b128 v[144:147], v2 offset:4096
    ds_read_b128 v[148:151], v2 offset:6144
    ds_read_b64_tr_b16 v[168:169], v3 offset:0
    ds_read_b64_tr_b16 v[170:171], v3 offset:256
    ds_read_b64_tr_b16 v[172:173], v4 offset:0
    ds_read_b64_tr_b16 v[174:175], v4 offset:256
    ds_read_b64_tr_b16 v[176:177], v3 offset:2048
    ds_read_b64_tr_b16 v[178:179], v3 offset:2304
    ds_read_b64_tr_b16 v[180:181], v4 offset:2048
    ds_read_b64_tr_b16 v[182:183], v4 offset:2304
    ds_read_b64_tr_b16 v[184:185], v3 offset:4096
    ds_read_b64_tr_b16 v[186:187], v3 offset:4352
    ds_read_b64_tr_b16 v[188:189], v4 offset:4096
    ds_read_b64_tr_b16 v[190:191], v4 offset:4352
    ds_read_b64_tr_b16 v[192:193], v3 offset:6144
    ds_read_b64_tr_b16 v[194:195], v3 offset:6400
    ds_read_b64_tr_b16 v[196:197], v4 offset:6144
    ds_read_b64_tr_b16 v[198:199], v4 offset:6400
    s_waitcnt lgkmcnt(0)
    s_barrier
    s_mov_b32 s77, 4
    s_setprio 1
    .p2align 3
L_main:
    v_mfma_f32_16x16x32_bf16 v[8:11], v[168:171], v[136:139], v[8:11]
    ds_read_b128 v[152:155], v5 offset:0
    v_mfma_f32_16x16x32_bf16 v[12:15], v[168:171], v[140:143], v[12:15]
    ds_read_b128 v[156:159], v5 offset:2048
    v_mfma_f32_16x16x32_bf16 v[16:19], v[168:171], v[144:147], v[16:19]
    ds_read_b128 v[160:163], v5 offset:4096
    v_mfma_f32_16x16x32_bf16 v[20:23], v[168:171], v[148:151], v[20:23]
    ds_read_b128 v[164:167], v5 offset:6144
    v_mfma_f32_16x16x32_bf16 v[24:27], v[172:175], v[136:139], v[24:27]
    ds_read_b64_tr_b16 v[200:201], v3 offset:16384
    v_mfma_f32_16x16x32_bf16 v[28:31], v[172:175], v[140:143], v[28:31]
    ds_read_b64_tr_b16 v[202:203], v3 offset:16640
    v_mfma_f32_16x16x32_bf16 v[32:35], v[172:175], v[144:147], v[32:35]
    ds_read_b64_tr_b16 v[204:205], v4 offset:16384
    v_mfma_f32_16x16x32_bf16 v[36:39], v[172:175], v[148:151], v[36:39]
    ds_read_b64_tr_b16 v[206:207], v4 offset:16640
    v_mfma_f32_16x16x32_bf16 v[40:43], v[176:179], v[136:139], v[40:43]
    ds_read_b64_tr_b16 v[208:209], v3 offset:18432
    v_mfma_f32_16x16x32_bf16 v[44:47], v[176:179], v[140:143], v[44:47]
    ds_read_b64_tr_b16 v[210:211], v3 offset:18688
    v_mfma_f32_16x16x32_bf16 v[48:51], v[176:179], v[144:147], v[48:51]
    ds_read_b64_tr_b16 v[212:213], v4 offset:18432
    v_mfma_f32_16x16x32_bf16 v[52:55], v[176:179], v[148:151], v[52:55]
    ds_read_b64_tr_b16 v[214:215], v4 offset:18688
    v_mfma_f32_16x16x32_bf16 v[56:59], v[180:183], v[136:139], v[56:59]
    ds_read_b64_tr_b16 v[216:217], v3 offset:20480
    v_mfma_f32_16x16x32_bf16 v[60:63], v[180:183], v[140:143], v[60:63]
    ds_read_b64_tr_b16 v[218:219], v3 offset:20736
    v_mfma_f32_16x16x32_bf16 v[64:67], v[180:183], v[144:147], v[64:67]
    ds_read_b64_tr_b16 v[220:221], v4 offset:20480
    v_mfma_f32_16x16x32_bf16 v[68:71], v[180:183], v[148:151], v[68:71]
    ds_read_b64_tr_b16 v[222:223], v4 offset:20736
    v_mfma_f32_16x16x32_bf16 v[72:75], v[184:187], v[136:139], v[72:75]
    ds_read_b64_tr_b16 v[224:225], v3 offset:22528
    v_mfma_f32_16x16x32_bf16 v[76:79], v[184:187], v[140:143], v[76:79]
    ds_read_b64_tr_b16 v[226:227], v3 offset:22784
    v_mfma_f32_16x16x32_bf16 v[80:83], v[184:187], v[144:147], v[80:83]
    ds_read_b64_tr_b16 v[228:229], v4 offset:22528
    v_mfma_f32_16x16x32_bf16 v[84:87], v[184:187], v[148:151], v[84:87]
    ds_read_b64_tr_b16 v[230:231], v4 offset:22784
    v_mfma_f32_16x16x32_bf16 v[88:91], v[188:191], v[136:139], v[88:91]
    v_mfma_f32_16x16x32_bf16 v[92:95], v[188:191], v[140:143], v[92:95]
    v_mfma_f32_16x16x32_bf16 v[96:99], v[188:191], v[144:147], v[96:99]
    v_mfma_f32_16x16x32_bf16 v[100:103], v[188:191], v[148:151], v[100:103]
    v_mfma_f32_16x16x32_bf16 v[104:107], v[192:195], v[136:139], v[104:107]
    v_mfma_f32_16x16x32_bf16 v[108:111], v[192:195], v[140:143], v[108:111]
    v_mfma_f32_16x16x32_bf16 v[112:115], v[192:195], v[144:147], v[112:115]
    v_mfma_f32_16x16x32_bf16 v[116:119], v[192:195], v[148:151], v[116:119]
    v_mfma_f32_16x16x32_bf16 v[120:123], v[196:199], v[136:139], v[120:123]
    v_mfma_f32_16x16x32_bf16 v[124:127], v[196:199], v[140:143], v[124:127]
    v_mfma_f32_16x16x32_bf16 v[128:131], v[196:199], v[144:147], v[128:131]
    v_mfma_f32_16x16x32_bf16 v[132:135], v[196:199], v[148:151], v[132:135]
    s_waitcnt lgkmcnt(0)
    s_barrier
    v_mfma_f32_16x16x32_bf16 v[8:11], v[200:203], v[152:155], v[8:11]
    ds_read_b128 v[136:139], v2 offset:16384
    v_mfma_f32_16x16x32_bf16 v[12:15], v[200:203], v[156:159], v[12:15]
    ds_read_b128 v[140:143], v2 offset:18432
    v_mfma_f32_16x16x32_bf16 v[16:19], v[200:203], v[160:163], v[16:19]
    ds_read_b128 v[144:147], v2 offset:20480
    v_mfma_f32_16x16x32_bf16 v[20:23], v[200:203], v[164:167], v[20:23]
    ds_read_b128 v[148:151], v2 offset:22528
    v_mfma_f32_16x16x32_bf16 v[24:27], v[204:207], v[152:155], v[24:27]
    ds_read_b64_tr_b16 v[168:169], v3 offset:32768
    v_mfma_f32_16x16x32_bf16 v[28:31], v[204:207], v[156:159], v[28:31]
    ds_read_b64_tr_b16 v[170:171], v3 offset:33024
    v_mfma_f32_16x16x32_bf16 v[32:35], v[204:207], v[160:163], v[32:35]
    ds_read_b64_tr_b16 v[172:173], v4 offset:32768
    v_mfma_f32_16x16x32_bf16 v[36:39], v[204:207], v[164:167], v[36:39]
    ds_read_b64_tr_b16 v[174:175], v4 offset:33024
    v_mfma_f32_16x16x32_bf16 v[40:43], v[208:211], v[152:155], v[40:43]
    ds_read_b64_tr_b16 v[176:177], v3 offset:34816
    v_mfma_f32_16x16x32_bf16 v[44:47], v[208:211], v[156:159], v[44:47]
    ds_read_b64_tr_b16 v[178:179], v3 offset:35072
    v_mfma_f32_16x16x32_bf16 v[48:51], v[208:211], v[160:163], v[48:51]
    ds_read_b64_tr_b16 v[180:181], v4 offset:34816
    v_mfma_f32_16x16x32_bf16 v[52:55], v[208:211], v[164:167], v[52:55]
    ds_read_b64_tr_b16 v[182:183], v4 offset:35072
    v_mfma_f32_16x16x32_bf16 v[56:59], v[212:215], v[152:155], v[56:59]
    ds_read_b64_tr_b16 v[184:185], v3 offset:36864
    v_mfma_f32_16x16x32_bf16 v[60:63], v[212:215], v[156:159], v[60:63]
    ds_read_b64_tr_b16 v[186:187], v3 offset:37120
    v_mfma_f32_16x16x32_bf16 v[64:67], v[212:215], v[160:163], v[64:67]
    ds_read_b64_tr_b16 v[188:189], v4 offset:36864
    v_mfma_f32_16x16x32_bf16 v[68:71], v[212:215], v[164:167], v[68:71]
    ds_read_b64_tr_b16 v[190:191], v4 offset:37120
    v_mfma_f32_16x16x32_bf16 v[72:75], v[216:219], v[152:155], v[72:75]
    ds_read_b64_tr_b16 v[192:193], v3 offset:38912
    v_mfma_f32_16x16x32_bf16 v[76:79], v[216:219], v[156:159], v[76:79]
    ds_read_b64_tr_b16 v[194:195], v3 offset:39168
    v_mfma_f32_16x16x32_bf16 v[80:83], v[216:219], v[160:163], v[80:83]
    ds_read_b64_tr_b16 v[196:197], v4 offset:38912
    v_mfma_f32_16x16x32_bf16 v[84:87], v[216:219], v[164:167], v[84:87]
    ds_read_b64_tr_b16 v[198:199], v4 offset:39168
    v_mfma_f32_16x16x32_bf16 v[88:91], v[220:223], v[152:155], v[88:91]
    v_mfma_f32_16x16x32_bf16 v[92:95], v[220:223], v[156:159], v[92:95]
    v_mfma_f32_16x16x32_bf16 v[96:99], v[220:223], v[160:163], v[96:99]
    v_mfma_f32_16x16x32_bf16 v[100:103], v[220:223], v[164:167], v[100:103]
    v_mfma_f32_16x16x32_bf16 v[104:107], v[224:227], v[152:155], v[104:107]
    v_mfma_f32_16x16x32_bf16 v[108:111], v[224:227], v[156:159], v[108:111]
    v_mfma_f32_16x16x32_bf16 v[112:115], v[224:227], v[160:163], v[112:115]
    v_mfma_f32_16x16x32_bf16 v[116:119], v[224:227], v[164:167], v[116:119]
    v_mfma_f32_16x16x32_bf16 v[120:123], v[228:231], v[152:155], v[120:123]
    v_mfma_f32_16x16x32_bf16 v[124:127], v[228:231], v[156:159], v[124:127]
    v_mfma_f32_16x16x32_bf16 v[128:131], v[228:231], v[160:163], v[128:131]
    v_mfma_f32_16x16x32_bf16 v[132:135], v[228:231], v[164:167], v[132:135]
    s_waitcnt lgkmcnt(0)
    s_barrier
    v_mfma_f32_16x16x32_bf16 v[8:11], v[168:171], v[136:139], v[8:11]
    ds_read_b128 v[152:155], v5 offset:16384
    v_mfma_f32_16x16x32_bf16 v[12:15], v[168:171], v[140:143], v[12:15]
    ds_read_b128 v[156:159], v5 offset:18432
    v_mfma_f32_16x16x32_bf16 v[16:19], v[168:171], v[144:147], v[16:19]
    ds_read_b128 v[160:163], v5 offset:20480
    v_mfma_f32_16x16x32_bf16 v[20:23], v[168:171], v[148:151], v[20:23]
    ds_read_b128 v[164:167], v5 offset:22528
    v_mfma_f32_16x16x32_bf16 v[24:27], v[172:175], v[136:139], v[24:27]
    ds_read_b64_tr_b16 v[200:201], v3 offset:49152
    v_mfma_f32_16x16x32_bf16 v[28:31], v[172:175], v[140:143], v[28:31]
    ds_read_b64_tr_b16 v[202:203], v3 offset:49408
    v_mfma_f32_16x16x32_bf16 v[32:35], v[172:175], v[144:147], v[32:35]
    ds_read_b64_tr_b16 v[204:205], v4 offset:49152
    v_mfma_f32_16x16x32_bf16 v[36:39], v[172:175], v[148:151], v[36:39]
    ds_read_b64_tr_b16 v[206:207], v4 offset:49408
    v_mfma_f32_16x16x32_bf16 v[40:43], v[176:179], v[136:139], v[40:43]
    ds_read_b64_tr_b16 v[208:209], v3 offset:51200
    v_mfma_f32_16x16x32_bf16 v[44:47], v[176:179], v[140:143], v[44:47]
    ds_read_b64_tr_b16 v[210:211], v3 offset:51456
    v_mfma_f32_16x16x32_bf16 v[48:51], v[176:179], v[144:147], v[48:51]
    ds_read_b64_tr_b16 v[212:213], v4 offset:51200
    v_mfma_f32_16x16x32_bf16 v[52:55], v[176:179], v[148:151], v[52:55]
    ds_read_b64_tr_b16 v[214:215], v4 offset:51456
    v_mfma_f32_16x16x32_bf16 v[56:59], v[180:183], v[136:139], v[56:59]
    ds_read_b64_tr_b16 v[216:217], v3 offset:53248
    v_mfma_f32_16x16x32_bf16 v[60:63], v[180:183], v[140:143], v[60:63]
    ds_read_b64_tr_b16 v[218:219], v3 offset:53504
    v_mfma_f32_16x16x32_bf16 v[64:67], v[180:183], v[144:147], v[64:67]
    ds_read_b64_tr_b16 v[220:221], v4 offset:53248
    v_mfma_f32_16x16x32_bf16 v[68:71], v[180:183], v[148:151], v[68:71]
    ds_read_b64_tr_b16 v[222:223], v4 offset:53504
    v_mfma_f32_16x16x32_bf16 v[72:75], v[184:187], v[136:139], v[72:75]
    ds_read_b64_tr_b16 v[224:225], v3 offset:55296
    v_mfma_f32_16x16x32_bf16 v[76:79], v[184:187], v[140:143], v[76:79]
    ds_read_b64_tr_b16 v[226:227], v3 offset:55552
    v_mfma_f32_16x16x32_bf16 v[80:83], v[184:187], v[144:147], v[80:83]
    ds_read_b64_tr_b16 v[228:229], v4 offset:55296
    v_mfma_f32_16x16x32_bf16 v[84:87], v[184:187], v[148:151], v[84:87]
    ds_read_b64_tr_b16 v[230:231], v4 offset:55552
    v_mfma_f32_16x16x32_bf16 v[88:91], v[188:191], v[136:139], v[88:91]
    v_mfma_f32_16x16x32_bf16 v[92:95], v[188:191], v[140:143], v[92:95]
    v_mfma_f32_16x16x32_bf16 v[96:99], v[188:191], v[144:147], v[96:99]
    v_mfma_f32_16x16x32_bf16 v[100:103], v[188:191], v[148:151], v[100:103]
    v_mfma_f32_16x16x32_bf16 v[104:107], v[192:195], v[136:139], v[104:107]
    v_mfma_f32_16x16x32_bf16 v[108:111], v[192:195], v[140:143], v[108:111]
    v_mfma_f32_16x16x32_bf16 v[112:115], v[192:195], v[144:147], v[112:115]
    v_mfma_f32_16x16x32_bf16 v[116:119], v[192:195], v[148:151], v[116:119]
    v_mfma_f32_16x16x32_bf16 v[120:123], v[196:199], v[136:139], v[120:123]
    v_mfma_f32_16x16x32_bf16 v[124:127], v[196:199], v[140:143], v[124:127]
    v_mfma_f32_16x16x32_bf16 v[128:131], v[196:199], v[144:147], v[128:131]
    v_mfma_f32_16x16x32_bf16 v[132:135], v[196:199], v[148:151], v[132:135]
    s_waitcnt lgkmcnt(0)
    s_barrier
    v_mfma_f32_16x16x32_bf16 v[8:11], v[200:203], v[152:155], v[8:11]
    v_xor_b32 v2, 0x8000, v2
    v_mfma_f32_16x16x32_bf16 v[12:15], v[200:203], v[156:159], v[12:15]
    v_xor_b32 v5, 0x8000, v5
    v_mfma_f32_16x16x32_bf16 v[16:19], v[200:203], v[160:163], v[16:19]
    ds_read_b128 v[136:139], v2 offset:0
    v_mfma_f32_16x16x32_bf16 v[20:23], v[200:203], v[164:167], v[20:23]
    ds_read_b128 v[140:143], v2 offset:2048
    v_mfma_f32_16x16x32_bf16 v[24:27], v[204:207], v[152:155], v[24:27]
    ds_read_b128 v[144:147], v2 offset:4096
    v_mfma_f32_16x16x32_bf16 v[28:31], v[204:207], v[156:159], v[28:31]
    ds_read_b128 v[148:151], v2 offset:6144
    v_mfma_f32_16x16x32_bf16 v[32:35], v[204:207], v[160:163], v[32:35]
    ds_read_b64_tr_b16 v[168:169], v3 offset:0
    v_mfma_f32_16x16x32_bf16 v[36:39], v[204:207], v[164:167], v[36:39]
    ds_read_b64_tr_b16 v[170:171], v3 offset:256
    v_mfma_f32_16x16x32_bf16 v[40:43], v[208:211], v[152:155], v[40:43]
    ds_read_b64_tr_b16 v[172:173], v4 offset:0
    v_mfma_f32_16x16x32_bf16 v[44:47], v[208:211], v[156:159], v[44:47]
    ds_read_b64_tr_b16 v[174:175], v4 offset:256
    v_mfma_f32_16x16x32_bf16 v[48:51], v[208:211], v[160:163], v[48:51]
    ds_read_b64_tr_b16 v[176:177], v3 offset:2048
    v_mfma_f32_16x16x32_bf16 v[52:55], v[208:211], v[164:167], v[52:55]
    ds_read_b64_tr_b16 v[178:179], v3 offset:2304
    v_mfma_f32_16x16x32_bf16 v[56:59], v[212:215], v[152:155], v[56:59]
    ds_read_b64_tr_b16 v[180:181], v4 offset:2048
    v_mfma_f32_16x16x32_bf16 v[60:63], v[212:215], v[156:159], v[60:63]
    ds_read_b64_tr_b16 v[182:183], v4 offset:2304
    v_mfma_f32_16x16x32_bf16 v[64:67], v[212:215], v[160:163], v[64:67]
    ds_read_b64_tr_b16 v[184:185], v3 offset:4096
    v_mfma_f32_16x16x32_bf16 v[68:71], v[212:215], v[164:167], v[68:71]
    ds_read_b64_tr_b16 v[186:187], v3 offset:4352
    v_mfma_f32_16x16x32_bf16 v[72:75], v[216:219], v[152:155], v[72:75]
    ds_read_b64_tr_b16 v[188:189], v4 offset:4096
    v_mfma_f32_16x16x32_bf16 v[76:79], v[216:219], v[156:159], v[76:79]
    ds_read_b64_tr_b16 v[190:191], v4 offset:4352
    v_mfma_f32_16x16x32_bf16 v[80:83], v[216:219], v[160:163], v[80:83]
    ds_read_b64_tr_b16 v[192:193], v3 offset:6144
    v_mfma_f32_16x16x32_bf16 v[84:87], v[216:219], v[164:167], v[84:87]
    ds_read_b64_tr_b16 v[194:195], v3 offset:6400
    v_mfma_f32_16x16x32_bf16 v[88:91], v[220:223], v[152:155], v[88:91]
    ds_read_b64_tr_b16 v[196:197], v4 offset:6144
    v_mfma_f32_16x16x32_bf16 v[92:95], v[220:223], v[156:159], v[92:95]
    ds_read_b64_tr_b16 v[198:199], v4 offset:6400
    v_mfma_f32_16x16x32_bf16 v[96:99], v[220:223], v[160:163], v[96:99]
    v_mfma_f32_16x16x32_bf16 v[100:103], v[220:223], v[164:167], v[100:103]
    v_mfma_f32_16x16x32_bf16 v[104:107], v[224:227], v[152:155], v[104:107]
    v_mfma_f32_16x16x32_bf16 v[108:111], v[224:227], v[156:159], v[108:111]
    v_mfma_f32_16x16x32_bf16 v[112:115], v[224:227], v[160:163], v[112:115]
    v_mfma_f32_16x16x32_bf16 v[116:119], v[224:227], v[164:167], v[116:119]
    v_mfma_f32_16x16x32_bf16 v[120:123], v[228:231], v[152:155], v[120:123]
    s_sub_u32 s77, s77, 1
    v_mfma_f32_16x16x32_bf16 v[124:127], v[228:231], v[156:159], v[124:127]
    s_cmp_lg_u32 s77, 0
    v_mfma_f32_16x16x32_bf16 v[128:131], v[228:231], v[160:163], v[128:131]
    v_mfma_f32_16x16x32_bf16 v[132:135], v[228:231], v[164:167], v[132:135]
    s_waitcnt lgkmcnt(0)
    s_barrier
    s_cbranch_scc1 L_main
    v_mfma_f32_16x16x32_bf16 v[8:11], v[168:171], v[136:139], v[8:11]
    ds_read_b128 v[152:155], v5 offset:0
    v_mfma_f32_16x16x32_bf16 v[12:15], v[168:171], v[140:143], v[12:15]
    ds_read_b128 v[156:159], v5 offset:2048
    v_mfma_f32_16x16x32_bf16 v[16:19], v[168:171], v[144:147], v[16:19]
    ds_read_b128 v[160:163], v5 offset:4096
    v_mfma_f32_16x16x32_bf16 v[20:23], v[168:171], v[148:151], v[20:23]
    ds_read_b128 v[164:167], v5 offset:6144
    v_mfma_f32_16x16x32_bf16 v[24:27], v[172:175], v[136:139], v[24:27]
    ds_read_b64_tr_b16 v[200:201], v3 offset:16384
    v_mfma_f32_16x16x32_bf16 v[28:31], v[172:175], v[140:143], v[28:31]
    ds_read_b64_tr_b16 v[202:203], v3 offset:16640
    v_mfma_f32_16x16x32_bf16 v[32:35], v[172:175], v[144:147], v[32:35]
    ds_read_b64_tr_b16 v[204:205], v4 offset:16384
    v_mfma_f32_16x16x32_bf16 v[36:39], v[172:175], v[148:151], v[36:39]
    ds_read_b64_tr_b16 v[206:207], v4 offset:16640
    v_mfma_f32_16x16x32_bf16 v[40:43], v[176:179], v[136:139], v[40:43]
    ds_read_b64_tr_b16 v[208:209], v3 offset:18432
    v_mfma_f32_16x16x32_bf16 v[44:47], v[176:179], v[140:143], v[44:47]
    ds_read_b64_tr_b16 v[210:211], v3 offset:18688
    v_mfma_f32_16x16x32_bf16 v[48:51], v[176:179], v[144:147], v[48:51]
    ds_read_b64_tr_b16 v[212:213], v4 offset:18432
    v_mfma_f32_16x16x32_bf16 v[52:55], v[176:179], v[148:151], v[52:55]
    ds_read_b64_tr_b16 v[214:215], v4 offset:18688
    v_mfma_f32_16x16x32_bf16 v[56:59], v[180:183], v[136:139], v[56:59]
    ds_read_b64_tr_b16 v[216:217], v3 offset:20480
    v_mfma_f32_16x16x32_bf16 v[60:63], v[180:183], v[140:143], v[60:63]
    ds_read_b64_tr_b16 v[218:219], v3 offset:20736
    v_mfma_f32_16x16x32_bf16 v[64:67], v[180:183], v[144:147], v[64:67]
    ds_read_b64_tr_b16 v[220:221], v4 offset:20480
    v_mfma_f32_16x16x32_bf16 v[68:71], v[180:183], v[148:151], v[68:71]
    ds_read_b64_tr_b16 v[222:223], v4 offset:20736
    v_mfma_f32_16x16x32_bf16 v[72:75], v[184:187], v[136:139], v[72:75]
    ds_read_b64_tr_b16 v[224:225], v3 offset:22528
    v_mfma_f32_16x16x32_bf16 v[76:79], v[184:187], v[140:143], v[76:79]
    ds_read_b64_tr_b16 v[226:227], v3 offset:22784
    v_mfma_f32_16x16x32_bf16 v[80:83], v[184:187], v[144:147], v[80:83]
    ds_read_b64_tr_b16 v[228:229], v4 offset:22528
    v_mfma_f32_16x16x32_bf16 v[84:87], v[184:187], v[148:151], v[84:87]
    ds_read_b64_tr_b16 v[230:231], v4 offset:22784
    v_mfma_f32_16x16x32_bf16 v[88:91], v[188:191], v[136:139], v[88:91]
    v_mfma_f32_16x16x32_bf16 v[92:95], v[188:191], v[140:143], v[92:95]
    v_mfma_f32_16x16x32_bf16 v[96:99], v[188:191], v[144:147], v[96:99]
    v_mfma_f32_16x16x32_bf16 v[100:103], v[188:191], v[148:151], v[100:103]
    v_mfma_f32_16x16x32_bf16 v[104:107], v[192:195], v[136:139], v[104:107]
    v_mfma_f32_16x16x32_bf16 v[108:111], v[192:195], v[140:143], v[108:111]
    v_mfma_f32_16x16x32_bf16 v[112:115], v[192:195], v[144:147], v[112:115]
    v_mfma_f32_16x16x32_bf16 v[116:119], v[192:195], v[148:151], v[116:119]
    v_mfma_f32_16x16x32_bf16 v[120:123], v[196:199], v[136:139], v[120:123]
    v_mfma_f32_16x16x32_bf16 v[124:127], v[196:199], v[140:143], v[124:127]
    v_mfma_f32_16x16x32_bf16 v[128:131], v[196:199], v[144:147], v[128:131]
    v_mfma_f32_16x16x32_bf16 v[132:135], v[196:199], v[148:151], v[132:135]
    s_waitcnt lgkmcnt(0)
    s_barrier
    v_mfma_f32_16x16x32_bf16 v[8:11], v[200:203], v[152:155], v[8:11]
    ds_read_b128 v[136:139], v2 offset:16384
    v_mfma_f32_16x16x32_bf16 v[12:15], v[200:203], v[156:159], v[12:15]
    ds_read_b128 v[140:143], v2 offset:18432
    v_mfma_f32_16x16x32_bf16 v[16:19], v[200:203], v[160:163], v[16:19]
    ds_read_b128 v[144:147], v2 offset:20480
    v_mfma_f32_16x16x32_bf16 v[20:23], v[200:203], v[164:167], v[20:23]
    ds_read_b128 v[148:151], v2 offset:22528
    v_mfma_f32_16x16x32_bf16 v[24:27], v[204:207], v[152:155], v[24:27]
    ds_read_b64_tr_b16 v[168:169], v3 offset:32768
    v_mfma_f32_16x16x32_bf16 v[28:31], v[204:207], v[156:159], v[28:31]
    ds_read_b64_tr_b16 v[170:171], v3 offset:33024
    v_mfma_f32_16x16x32_bf16 v[32:35], v[204:207], v[160:163], v[32:35]
    ds_read_b64_tr_b16 v[172:173], v4 offset:32768
    v_mfma_f32_16x16x32_bf16 v[36:39], v[204:207], v[164:167], v[36:39]
    ds_read_b64_tr_b16 v[174:175], v4 offset:33024
    v_mfma_f32_16x16x32_bf16 v[40:43], v[208:211], v[152:155], v[40:43]
    ds_read_b64_tr_b16 v[176:177], v3 offset:34816
    v_mfma_f32_16x16x32_bf16 v[44:47], v[208:211], v[156:159], v[44:47]
    ds_read_b64_tr_b16 v[178:179], v3 offset:35072
    v_mfma_f32_16x16x32_bf16 v[48:51], v[208:211], v[160:163], v[48:51]
    ds_read_b64_tr_b16 v[180:181], v4 offset:34816
    v_mfma_f32_16x16x32_bf16 v[52:55], v[208:211], v[164:167], v[52:55]
    ds_read_b64_tr_b16 v[182:183], v4 offset:35072
    v_mfma_f32_16x16x32_bf16 v[56:59], v[212:215], v[152:155], v[56:59]
    ds_read_b64_tr_b16 v[184:185], v3 offset:36864
    v_mfma_f32_16x16x32_bf16 v[60:63], v[212:215], v[156:159], v[60:63]
    ds_read_b64_tr_b16 v[186:187], v3 offset:37120
    v_mfma_f32_16x16x32_bf16 v[64:67], v[212:215], v[160:163], v[64:67]
    ds_read_b64_tr_b16 v[188:189], v4 offset:36864
    v_mfma_f32_16x16x32_bf16 v[68:71], v[212:215], v[164:167], v[68:71]
    ds_read_b64_tr_b16 v[190:191], v4 offset:37120
    v_mfma_f32_16x16x32_bf16 v[72:75], v[216:219], v[152:155], v[72:75]
    ds_read_b64_tr_b16 v[192:193], v3 offset:38912
    v_mfma_f32_16x16x32_bf16 v[76:79], v[216:219], v[156:159], v[76:79]
    ds_read_b64_tr_b16 v[194:195], v3 offset:39168
    v_mfma_f32_16x16x32_bf16 v[80:83], v[216:219], v[160:163], v[80:83]
    ds_read_b64_tr_b16 v[196:197], v4 offset:38912
    v_mfma_f32_16x16x32_bf16 v[84:87], v[216:219], v[164:167], v[84:87]
    ds_read_b64_tr_b16 v[198:199], v4 offset:39168
    v_mfma_f32_16x16x32_bf16 v[88:91], v[220:223], v[152:155], v[88:91]
    v_mfma_f32_16x16x32_bf16 v[92:95], v[220:223], v[156:159], v[92:95]
    v_mfma_f32_16x16x32_bf16 v[96:99], v[220:223], v[160:163], v[96:99]
    v_mfma_f32_16x16x32_bf16 v[100:103], v[220:223], v[164:167], v[100:103]
    v_mfma_f32_16x16x32_bf16 v[104:107], v[224:227], v[152:155], v[104:107]
    v_mfma_f32_16x16x32_bf16 v[108:111], v[224:227], v[156:159], v[108:111]
    v_mfma_f32_16x16x32_bf16 v[112:115], v[224:227], v[160:163], v[112:115]
    v_mfma_f32_16x16x32_bf16 v[116:119], v[224:227], v[164:167], v[116:119]
    v_mfma_f32_16x16x32_bf16 v[120:123], v[228:231], v[152:155], v[120:123]
    v_mfma_f32_16x16x32_bf16 v[124:127], v[228:231], v[156:159], v[124:127]
    v_mfma_f32_16x16x32_bf16 v[128:131], v[228:231], v[160:163], v[128:131]
    v_mfma_f32_16x16x32_bf16 v[132:135], v[228:231], v[164:167], v[132:135]
    s_waitcnt lgkmcnt(0)
    s_barrier
    v_mfma_f32_16x16x32_bf16 v[8:11], v[168:171], v[136:139], v[8:11]
    ds_read_b128 v[152:155], v5 offset:16384
    v_mfma_f32_16x16x32_bf16 v[12:15], v[168:171], v[140:143], v[12:15]
    ds_read_b128 v[156:159], v5 offset:18432
    v_mfma_f32_16x16x32_bf16 v[16:19], v[168:171], v[144:147], v[16:19]
    ds_read_b128 v[160:163], v5 offset:20480
    v_mfma_f32_16x16x32_bf16 v[20:23], v[168:171], v[148:151], v[20:23]
    ds_read_b128 v[164:167], v5 offset:22528
    v_mfma_f32_16x16x32_bf16 v[24:27], v[172:175], v[136:139], v[24:27]
    ds_read_b64_tr_b16 v[200:201], v3 offset:49152
    v_mfma_f32_16x16x32_bf16 v[28:31], v[172:175], v[140:143], v[28:31]
    ds_read_b64_tr_b16 v[202:203], v3 offset:49408
    v_mfma_f32_16x16x32_bf16 v[32:35], v[172:175], v[144:147], v[32:35]
    ds_read_b64_tr_b16 v[204:205], v4 offset:49152
    v_mfma_f32_16x16x32_bf16 v[36:39], v[172:175], v[148:151], v[36:39]
    ds_read_b64_tr_b16 v[206:207], v4 offset:49408
    v_mfma_f32_16x16x32_bf16 v[40:43], v[176:179], v[136:139], v[40:43]
    ds_read_b64_tr_b16 v[208:209], v3 offset:51200
    v_mfma_f32_16x16x32_bf16 v[44:47], v[176:179], v[140:143], v[44:47]
    ds_read_b64_tr_b16 v[210:211], v3 offset:51456
    v_mfma_f32_16x16x32_bf16 v[48:51], v[176:179], v[144:147], v[48:51]
    ds_read_b64_tr_b16 v[212:213], v4 offset:51200
    v_mfma_f32_16x16x32_bf16 v[52:55], v[176:179], v[148:151], v[52:55]
    ds_read_b64_tr_b16 v[214:215], v4 offset:51456
    v_mfma_f32_16x16x32_bf16 v[56:59], v[180:183], v[136:139], v[56:59]
    ds_read_b64_tr_b16 v[216:217], v3 offset:53248
    v_mfma_f32_16x16x32_bf16 v[60:63], v[180:183], v[140:143], v[60:63]
    ds_read_b64_tr_b16 v[218:219], v3 offset:53504
    v_mfma_f32_16x16x32_bf16 v[64:67], v[180:183], v[144:147], v[64:67]
    ds_read_b64_tr_b16 v[220:221], v4 offset:53248
    v_mfma_f32_16x16x32_bf16 v[68:71], v[180:183], v[148:151], v[68:71]
    ds_read_b64_tr_b16 v[222:223], v4 offset:53504
    v_mfma_f32_16x16x32_bf16 v[72:75], v[184:187], v[136:139], v[72:75]
    ds_read_b64_tr_b16 v[224:225], v3 offset:55296
    v_mfma_f32_16x16x32_bf16 v[76:79], v[184:187], v[140:143], v[76:79]
    ds_read_b64_tr_b16 v[226:227], v3 offset:55552
    v_mfma_f32_16x16x32_bf16 v[80:83], v[184:187], v[144:147], v[80:83]
    ds_read_b64_tr_b16 v[228:229], v4 offset:55296
    v_mfma_f32_16x16x32_bf16 v[84:87], v[184:187], v[148:151], v[84:87]
    ds_read_b64_tr_b16 v[230:231], v4 offset:55552
    v_mfma_f32_16x16x32_bf16 v[88:91], v[188:191], v[136:139], v[88:91]
    v_mfma_f32_16x16x32_bf16 v[92:95], v[188:191], v[140:143], v[92:95]
    v_mfma_f32_16x16x32_bf16 v[96:99], v[188:191], v[144:147], v[96:99]
    v_mfma_f32_16x16x32_bf16 v[100:103], v[188:191], v[148:151], v[100:103]
    v_mfma_f32_16x16x32_bf16 v[104:107], v[192:195], v[136:139], v[104:107]
    v_mfma_f32_16x16x32_bf16 v[108:111], v[192:195], v[140:143], v[108:111]
    v_mfma_f32_16x16x32_bf16 v[112:115], v[192:195], v[144:147], v[112:115]
    v_mfma_f32_16x16x32_bf16 v[116:119], v[192:195], v[148:151], v[116:119]
    v_mfma_f32_16x16x32_bf16 v[120:123], v[196:199], v[136:139], v[120:123]
    v_mfma_f32_16x16x32_bf16 v[124:127], v[196:199], v[140:143], v[124:127]
    v_mfma_f32_16x16x32_bf16 v[128:131], v[196:199], v[144:147], v[128:131]
    v_mfma_f32_16x16x32_bf16 v[132:135], v[196:199], v[148:151], v[132:135]
    s_waitcnt lgkmcnt(0)
    s_cmp_eq_u32 s33, 1
    s_cbranch_scc0 L_last_b
    s_mov_b32 s56, 13713408
    buffer_load_dword v255, v232, s[44:47], s56 offen sc1
    s_cmp_eq_u32 s75, 1
    s_cbranch_scc1 L_last_a1
    v_mfma_f32_16x16x32_bf16 v[8:11], v[200:203], v[152:155], v[8:11]
    v_mfma_f32_16x16x32_bf16 v[12:15], v[200:203], v[156:159], v[12:15]
    v_mfma_f32_16x16x32_bf16 v[16:19], v[200:203], v[160:163], v[16:19]
    v_mfma_f32_16x16x32_bf16 v[20:23], v[200:203], v[164:167], v[20:23]
    s_nop 4
    v_cvt_pk_bf16_f32 v8, v8, v9
    v_cvt_pk_bf16_f32 v9, v10, v11
    ds_write_b64 v235, v[8:9] offset:0
    v_mfma_f32_16x16x32_bf16 v[24:27], v[204:207], v[152:155], v[24:27]
    v_cvt_pk_bf16_f32 v12, v12, v13
    v_cvt_pk_bf16_f32 v13, v14, v15
    ds_write_b64 v235, v[12:13] offset:7808
    v_mfma_f32_16x16x32_bf16 v[28:31], v[204:207], v[156:159], v[28:31]
    v_cvt_pk_bf16_f32 v16, v16, v17
    v_cvt_pk_bf16_f32 v17, v18, v19
    ds_write_b64 v235, v[16:17] offset:15616
    v_mfma_f32_16x16x32_bf16 v[32:35], v[204:207], v[160:163], v[32:35]
    v_cvt_pk_bf16_f32 v20, v20, v21
    v_cvt_pk_bf16_f32 v21, v22, v23
    ds_write_b64 v235, v[20:21] offset:23424
    v_mfma_f32_16x16x32_bf16 v[36:39], v[204:207], v[164:167], v[36:39]
    v_cvt_pk_bf16_f32 v24, v24, v25
    v_cvt_pk_bf16_f32 v25, v26, v27
    ds_write_b64 v235, v[24:25] offset:32
    v_mfma_f32_16x16x32_bf16 v[40:43], v[208:211], v[152:155], v[40:43]
    v_cvt_pk_bf16_f32 v28, v28, v29
    v_cvt_pk_bf16_f32 v29, v30, v31
    ds_write_b64 v235, v[28:29] offset:7840
    v_mfma_f32_16x16x32_bf16 v[44:47], v[208:211], v[156:159], v[44:47]
    v_cvt_pk_bf16_f32 v32, v32, v33
    v_cvt_pk_bf16_f32 v33, v34, v35
    ds_write_b64 v235, v[32:33] offset:15648
    v_mfma_f32_16x16x32_bf16 v[48:51], v[208:211], v[160:163], v[48:51]
    v_cvt_pk_bf16_f32 v36, v36, v37
    v_cvt_pk_bf16_f32 v37, v38, v39
    ds_write_b64 v235, v[36:37] offset:23456
    v_mfma_f32_16x16x32_bf16 v[52:55], v[208:211], v[164:167], v[52:55]
    v_cvt_pk_bf16_f32 v40, v40, v41
    v_cvt_pk_bf16_f32 v41, v42, v43
    ds_write_b64 v235, v[40:41] offset:64
    v_mfma_f32_16x16x32_bf16 v[56:59], v[212:215], v[152:155], v[56:59]
    v_cvt_pk_bf16_f32 v44, v44, v45
    v_cvt_pk_bf16_f32 v45, v46, v47
    ds_write_b64 v235, v[44:45] offset:7872
    v_mfma_f32_16x16x32_bf16 v[60:63], v[212:215], v[156:159], v[60:63]
    v_cvt_pk_bf16_f32 v48, v48, v49
    v_cvt_pk_bf16_f32 v49, v50, v51
    ds_write_b64 v235, v[48:49] offset:15680
    v_mfma_f32_16x16x32_bf16 v[64:67], v[212:215], v[160:163], v[64:67]
    v_cvt_pk_bf16_f32 v52, v52, v53
    v_cvt_pk_bf16_f32 v53, v54, v55
    ds_write_b64 v235, v[52:53] offset:23488
    v_mfma_f32_16x16x32_bf16 v[68:71], v[212:215], v[164:167], v[68:71]
    v_cvt_pk_bf16_f32 v56, v56, v57
    v_cvt_pk_bf16_f32 v57, v58, v59
    ds_write_b64 v235, v[56:57] offset:96
    v_mfma_f32_16x16x32_bf16 v[72:75], v[216:219], v[152:155], v[72:75]
    v_cvt_pk_bf16_f32 v60, v60, v61
    v_cvt_pk_bf16_f32 v61, v62, v63
    ds_write_b64 v235, v[60:61] offset:7904
    v_mfma_f32_16x16x32_bf16 v[76:79], v[216:219], v[156:159], v[76:79]
    v_cvt_pk_bf16_f32 v64, v64, v65
    v_cvt_pk_bf16_f32 v65, v66, v67
    ds_write_b64 v235, v[64:65] offset:15712
    v_mfma_f32_16x16x32_bf16 v[80:83], v[216:219], v[160:163], v[80:83]
    v_cvt_pk_bf16_f32 v68, v68, v69
    v_cvt_pk_bf16_f32 v69, v70, v71
    ds_write_b64 v235, v[68:69] offset:23520
    v_mfma_f32_16x16x32_bf16 v[84:87], v[216:219], v[164:167], v[84:87]
    v_cvt_pk_bf16_f32 v72, v72, v73
    v_cvt_pk_bf16_f32 v73, v74, v75
    ds_write_b64 v235, v[72:73] offset:160
    v_mfma_f32_16x16x32_bf16 v[88:91], v[220:223], v[152:155], v[88:91]
    v_cvt_pk_bf16_f32 v76, v76, v77
    v_cvt_pk_bf16_f32 v77, v78, v79
    ds_write_b64 v235, v[76:77] offset:7968
    v_mfma_f32_16x16x32_bf16 v[92:95], v[220:223], v[156:159], v[92:95]
    v_cvt_pk_bf16_f32 v80, v80, v81
    v_cvt_pk_bf16_f32 v81, v82, v83
    ds_write_b64 v235, v[80:81] offset:15776
    v_mfma_f32_16x16x32_bf16 v[96:99], v[220:223], v[160:163], v[96:99]
    v_cvt_pk_bf16_f32 v84, v84, v85
    v_cvt_pk_bf16_f32 v85, v86, v87
    ds_write_b64 v235, v[84:85] offset:23584
    v_mfma_f32_16x16x32_bf16 v[100:103], v[220:223], v[164:167], v[100:103]
    v_cvt_pk_bf16_f32 v88, v88, v89
    v_cvt_pk_bf16_f32 v89, v90, v91
    ds_write_b64 v235, v[88:89] offset:192
    v_mfma_f32_16x16x32_bf16 v[104:107], v[224:227], v[152:155], v[104:107]
    v_cvt_pk_bf16_f32 v92, v92, v93
    v_cvt_pk_bf16_f32 v93, v94, v95
    ds_write_b64 v235, v[92:93] offset:8000
    v_mfma_f32_16x16x32_bf16 v[108:111], v[224:227], v[156:159], v[108:111]
    v_cvt_pk_bf16_f32 v96, v96, v97
    v_cvt_pk_bf16_f32 v97, v98, v99
    ds_write_b64 v235, v[96:97] offset:15808
    v_mfma_f32_16x16x32_bf16 v[112:115], v[224:227], v[160:163], v[112:115]
    v_cvt_pk_bf16_f32 v100, v100, v101
    v_cvt_pk_bf16_f32 v101, v102, v103
    ds_write_b64 v235, v[100:101] offset:23616
    v_mfma_f32_16x16x32_bf16 v[116:119], v[224:227], v[164:167], v[116:119]
    v_cvt_pk_bf16_f32 v104, v104, v105
    v_cvt_pk_bf16_f32 v105, v106, v107
    ds_write_b64 v235, v[104:105] offset:224
    v_mfma_f32_16x16x32_bf16 v[120:123], v[228:231], v[152:155], v[120:123]
    v_cvt_pk_bf16_f32 v108, v108, v109
    v_cvt_pk_bf16_f32 v109, v110, v111
    ds_write_b64 v235, v[108:109] offset:8032
    v_mfma_f32_16x16x32_bf16 v[124:127], v[228:231], v[156:159], v[124:127]
    v_cvt_pk_bf16_f32 v112, v112, v113
    v_cvt_pk_bf16_f32 v113, v114, v115
    ds_write_b64 v235, v[112:113] offset:15840
    v_mfma_f32_16x16x32_bf16 v[128:131], v[228:231], v[160:163], v[128:131]
    v_cvt_pk_bf16_f32 v116, v116, v117
    v_cvt_pk_bf16_f32 v117, v118, v119
    ds_write_b64 v235, v[116:117] offset:23648
    v_mfma_f32_16x16x32_bf16 v[132:135], v[228:231], v[164:167], v[132:135]
    v_cvt_pk_bf16_f32 v120, v120, v121
    v_cvt_pk_bf16_f32 v121, v122, v123
    ds_write_b64 v235, v[120:121] offset:256
    v_cvt_pk_bf16_f32 v124, v124, v125
    v_cvt_pk_bf16_f32 v125, v126, v127
    ds_write_b64 v235, v[124:125] offset:8064
    v_cvt_pk_bf16_f32 v128, v128, v129
    v_cvt_pk_bf16_f32 v129, v130, v131
    ds_write_b64 v235, v[128:129] offset:15872
    v_cvt_pk_bf16_f32 v132, v132, v133
    v_cvt_pk_bf16_f32 v133, v134, v135
    ds_write_b64 v235, v[132:133] offset:23680
    s_setprio 0
    s_branch L_epiA_w
L_last_a1:
    v_mfma_f32_16x16x32_bf16 v[8:11], v[200:203], v[152:155], v[8:11]
    v_mfma_f32_16x16x32_bf16 v[12:15], v[200:203], v[156:159], v[12:15]
    v_mfma_f32_16x16x32_bf16 v[16:19], v[200:203], v[160:163], v[16:19]
    v_mfma_f32_16x16x32_bf16 v[20:23], v[200:203], v[164:167], v[20:23]
    s_nop 4
    v_cvt_pk_bf16_f32 v8, v8, v9
    v_cvt_pk_bf16_f32 v9, v10, v11
    ds_write_b64 v235, v[8:9] offset:320
    v_mfma_f32_16x16x32_bf16 v[24:27], v[204:207], v[152:155], v[24:27]
    v_cvt_pk_bf16_f32 v12, v12, v13
    v_cvt_pk_bf16_f32 v13, v14, v15
    ds_write_b64 v235, v[12:13] offset:8128
    v_mfma_f32_16x16x32_bf16 v[28:31], v[204:207], v[156:159], v[28:31]
    v_cvt_pk_bf16_f32 v16, v16, v17
    v_cvt_pk_bf16_f32 v17, v18, v19
    ds_write_b64 v235, v[16:17] offset:15936
    v_mfma_f32_16x16x32_bf16 v[32:35], v[204:207], v[160:163], v[32:35]
    v_cvt_pk_bf16_f32 v20, v20, v21
    v_cvt_pk_bf16_f32 v21, v22, v23
    ds_write_b64 v235, v[20:21] offset:23744
    v_mfma_f32_16x16x32_bf16 v[36:39], v[204:207], v[164:167], v[36:39]
    v_cvt_pk_bf16_f32 v24, v24, v25
    v_cvt_pk_bf16_f32 v25, v26, v27
    ds_write_b64 v235, v[24:25] offset:352
    v_mfma_f32_16x16x32_bf16 v[40:43], v[208:211], v[152:155], v[40:43]
    v_cvt_pk_bf16_f32 v28, v28, v29
    v_cvt_pk_bf16_f32 v29, v30, v31
    ds_write_b64 v235, v[28:29] offset:8160
    v_mfma_f32_16x16x32_bf16 v[44:47], v[208:211], v[156:159], v[44:47]
    v_cvt_pk_bf16_f32 v32, v32, v33
    v_cvt_pk_bf16_f32 v33, v34, v35
    ds_write_b64 v235, v[32:33] offset:15968
    v_mfma_f32_16x16x32_bf16 v[48:51], v[208:211], v[160:163], v[48:51]
    v_cvt_pk_bf16_f32 v36, v36, v37
    v_cvt_pk_bf16_f32 v37, v38, v39
    ds_write_b64 v235, v[36:37] offset:23776
    v_mfma_f32_16x16x32_bf16 v[52:55], v[208:211], v[164:167], v[52:55]
    v_cvt_pk_bf16_f32 v40, v40, v41
    v_cvt_pk_bf16_f32 v41, v42, v43
    ds_write_b64 v235, v[40:41] offset:384
    v_mfma_f32_16x16x32_bf16 v[56:59], v[212:215], v[152:155], v[56:59]
    v_cvt_pk_bf16_f32 v44, v44, v45
    v_cvt_pk_bf16_f32 v45, v46, v47
    ds_write_b64 v235, v[44:45] offset:8192
    v_mfma_f32_16x16x32_bf16 v[60:63], v[212:215], v[156:159], v[60:63]
    v_cvt_pk_bf16_f32 v48, v48, v49
    v_cvt_pk_bf16_f32 v49, v50, v51
    ds_write_b64 v235, v[48:49] offset:16000
    v_mfma_f32_16x16x32_bf16 v[64:67], v[212:215], v[160:163], v[64:67]
    v_cvt_pk_bf16_f32 v52, v52, v53
    v_cvt_pk_bf16_f32 v53, v54, v55
    ds_write_b64 v235, v[52:53] offset:23808
    v_mfma_f32_16x16x32_bf16 v[68:71], v[212:215], v[164:167], v[68:71]
    v_cvt_pk_bf16_f32 v56, v56, v57
    v_cvt_pk_bf16_f32 v57, v58, v59
    ds_write_b64 v235, v[56:57] offset:416
    v_mfma_f32_16x16x32_bf16 v[72:75], v[216:219], v[152:155], v[72:75]
    v_cvt_pk_bf16_f32 v60, v60, v61
    v_cvt_pk_bf16_f32 v61, v62, v63
    ds_write_b64 v235, v[60:61] offset:8224
    v_mfma_f32_16x16x32_bf16 v[76:79], v[216:219], v[156:159], v[76:79]
    v_cvt_pk_bf16_f32 v64, v64, v65
    v_cvt_pk_bf16_f32 v65, v66, v67
    ds_write_b64 v235, v[64:65] offset:16032
    v_mfma_f32_16x16x32_bf16 v[80:83], v[216:219], v[160:163], v[80:83]
    v_cvt_pk_bf16_f32 v68, v68, v69
    v_cvt_pk_bf16_f32 v69, v70, v71
    ds_write_b64 v235, v[68:69] offset:23840
    v_mfma_f32_16x16x32_bf16 v[84:87], v[216:219], v[164:167], v[84:87]
    v_cvt_pk_bf16_f32 v72, v72, v73
    v_cvt_pk_bf16_f32 v73, v74, v75
    ds_write_b64 v236, v[72:73] offset:128
    v_mfma_f32_16x16x32_bf16 v[88:91], v[220:223], v[152:155], v[88:91]
    v_cvt_pk_bf16_f32 v76, v76, v77
    v_cvt_pk_bf16_f32 v77, v78, v79
    ds_write_b64 v236, v[76:77] offset:7936
    v_mfma_f32_16x16x32_bf16 v[92:95], v[220:223], v[156:159], v[92:95]
    v_cvt_pk_bf16_f32 v80, v80, v81
    v_cvt_pk_bf16_f32 v81, v82, v83
    ds_write_b64 v236, v[80:81] offset:15744
    v_mfma_f32_16x16x32_bf16 v[96:99], v[220:223], v[160:163], v[96:99]
    v_cvt_pk_bf16_f32 v84, v84, v85
    v_cvt_pk_bf16_f32 v85, v86, v87
    ds_write_b64 v236, v[84:85] offset:23552
    v_mfma_f32_16x16x32_bf16 v[100:103], v[220:223], v[164:167], v[100:103]
    v_cvt_pk_bf16_f32 v88, v88, v89
    v_cvt_pk_bf16_f32 v89, v90, v91
    ds_write_b64 v236, v[88:89] offset:288
    v_mfma_f32_16x16x32_bf16 v[104:107], v[224:227], v[152:155], v[104:107]
    v_cvt_pk_bf16_f32 v92, v92, v93
    v_cvt_pk_bf16_f32 v93, v94, v95
    ds_write_b64 v236, v[92:93] offset:8096
    v_mfma_f32_16x16x32_bf16 v[108:111], v[224:227], v[156:159], v[108:111]
    v_cvt_pk_bf16_f32 v96, v96, v97
    v_cvt_pk_bf16_f32 v97, v98, v99
    ds_write_b64 v236, v[96:97] offset:15904
    v_mfma_f32_16x16x32_bf16 v[112:115], v[224:227], v[160:163], v[112:115]
    v_cvt_pk_bf16_f32 v100, v100, v101
    v_cvt_pk_bf16_f32 v101, v102, v103
    ds_write_b64 v236, v[100:101] offset:23712
    v_mfma_f32_16x16x32_bf16 v[116:119], v[224:227], v[164:167], v[116:119]
    v_cvt_pk_bf16_f32 v104, v104, v105
    v_cvt_pk_bf16_f32 v105, v106, v107
    ds_write_b64 v236, v[104:105] offset:448
    v_mfma_f32_16x16x32_bf16 v[120:123], v[228:231], v[152:155], v[120:123]
    v_cvt_pk_bf16_f32 v108, v108, v109
    v_cvt_pk_bf16_f32 v109, v110, v111
    ds_write_b64 v236, v[108:109] offset:8256
    v_mfma_f32_16x16x32_bf16 v[124:127], v[228:231], v[156:159], v[124:127]
    v_cvt_pk_bf16_f32 v112, v112, v113
    v_cvt_pk_bf16_f32 v113, v114, v115
    ds_write_b64 v236, v[112:113] offset:16064
    v_mfma_f32_16x16x32_bf16 v[128:131], v[228:231], v[160:163], v[128:131]
    v_cvt_pk_bf16_f32 v116, v116, v117
    v_cvt_pk_bf16_f32 v117, v118, v119
    ds_write_b64 v236, v[116:117] offset:23872
    v_mfma_f32_16x16x32_bf16 v[132:135], v[228:231], v[164:167], v[132:135]
    s_setprio 0
    s_branch L_epiA_gate
L_last_b:
    v_mfma_f32_16x16x32_bf16 v[8:11], v[200:203], v[152:155], v[8:11]
    v_mfma_f32_16x16x32_bf16 v[12:15], v[200:203], v[156:159], v[12:15]
    v_mfma_f32_16x16x32_bf16 v[16:19], v[200:203], v[160:163], v[16:19]
    v_mfma_f32_16x16x32_bf16 v[20:23], v[200:203], v[164:167], v[20:23]
    v_mfma_f32_16x16x32_bf16 v[24:27], v[204:207], v[152:155], v[24:27]
    v_mfma_f32_16x16x32_bf16 v[28:31], v[204:207], v[156:159], v[28:31]
    v_mfma_f32_16x16x32_bf16 v[32:35], v[204:207], v[160:163], v[32:35]
    v_mfma_f32_16x16x32_bf16 v[36:39], v[204:207], v[164:167], v[36:39]
    v_mfma_f32_16x16x32_bf16 v[40:43], v[208:211], v[152:155], v[40:43]
    v_mfma_f32_16x16x32_bf16 v[44:47], v[208:211], v[156:159], v[44:47]
    v_mfma_f32_16x16x32_bf16 v[48:51], v[208:211], v[160:163], v[48:51]
    v_mfma_f32_16x16x32_bf16 v[52:55], v[208:211], v[164:167], v[52:55]
    v_mfma_f32_16x16x32_bf16 v[56:59], v[212:215], v[152:155], v[56:59]
    v_mfma_f32_16x16x32_bf16 v[60:63], v[212:215], v[156:159], v[60:63]
    v_mfma_f32_16x16x32_bf16 v[64:67], v[212:215], v[160:163], v[64:67]
    v_mfma_f32_16x16x32_bf16 v[68:71], v[212:215], v[164:167], v[68:71]
    v_mfma_f32_16x16x32_bf16 v[72:75], v[216:219], v[152:155], v[72:75]
    v_mfma_f32_16x16x32_bf16 v[76:79], v[216:219], v[156:159], v[76:79]
    v_mfma_f32_16x16x32_bf16 v[80:83], v[216:219], v[160:163], v[80:83]
    v_mfma_f32_16x16x32_bf16 v[84:87], v[216:219], v[164:167], v[84:87]
    v_mfma_f32_16x16x32_bf16 v[88:91], v[220:223], v[152:155], v[88:91]
    v_mfma_f32_16x16x32_bf16 v[92:95], v[220:223], v[156:159], v[92:95]
    v_mfma_f32_16x16x32_bf16 v[96:99], v[220:223], v[160:163], v[96:99]
    v_mfma_f32_16x16x32_bf16 v[100:103], v[220:223], v[164:167], v[100:103]
    v_mfma_f32_16x16x32_bf16 v[104:107], v[224:227], v[152:155], v[104:107]
    v_mfma_f32_16x16x32_bf16 v[108:111], v[224:227], v[156:159], v[108:111]
    v_mfma_f32_16x16x32_bf16 v[112:115], v[224:227], v[160:163], v[112:115]
    v_mfma_f32_16x16x32_bf16 v[116:119], v[224:227], v[164:167], v[116:119]
    v_mfma_f32_16x16x32_bf16 v[120:123], v[228:231], v[152:155], v[120:123]
    v_mfma_f32_16x16x32_bf16 v[124:127], v[228:231], v[156:159], v[124:127]
    v_mfma_f32_16x16x32_bf16 v[128:131], v[228:231], v[160:163], v[128:131]
    v_mfma_f32_16x16x32_bf16 v[132:135], v[228:231], v[164:167], v[132:135]
    s_setprio 0
    v_lshlrev_b32 v4, 4, v1
    s_mov_b32 s56, 13713408
    buffer_load_dword v255, v232, s[44:47], s56 offen sc1
    s_cmp_eq_u32 s33, 1
    s_cbranch_scc1 L_epiA
    s_lshl_b32 s56, s34, 1
    s_add_u32 s56, s56, s74
    s_mul_i32 s56, s56, 54
    s_lshl_b32 s57, s35, 3
    s_lshl_b32 s58, s75, 2
    s_add_u32 s57, s57, s58
    s_add_u32 s56, s56, s57
    s_lshl_b32 s56, s56, 12
    s_mov_b32 s63, s57
    v_max_f32 v8, 0, v8
    v_max_f32 v9, 0, v9
    v_max_f32 v10, 0, v10
    v_max_f32 v11, 0, v11
    v_pk_mul_f32 v[8:9], v[8:9], v[8:9]
    v_pk_mul_f32 v[10:11], v[10:11], v[10:11]
    v_cvt_pk_bf16_f32 v236, v8, v9
    v_cvt_pk_bf16_f32 v237, v10, v11
    v_max_f32 v24, 0, v24
    v_max_f32 v25, 0, v25
    v_max_f32 v26, 0, v26
    v_max_f32 v27, 0, v27
    v_pk_mul_f32 v[24:25], v[24:25], v[24:25]
    v_pk_mul_f32 v[26:27], v[26:27], v[26:27]
    v_cvt_pk_bf16_f32 v238, v24, v25
    v_cvt_pk_bf16_f32 v239, v26, v27
    buffer_store_dwordx4 v[236:239], v4, s[44:47], s56 offen offset:0 sc1
    v_max_f32 v12, 0, v12
    v_max_f32 v13, 0, v13
    v_max_f32 v14, 0, v14
    v_max_f32 v15, 0, v15
    v_pk_mul_f32 v[12:13], v[12:13], v[12:13]
    v_pk_mul_f32 v[14:15], v[14:15], v[14:15]
    v_cvt_pk_bf16_f32 v240, v12, v13
    v_cvt_pk_bf16_f32 v241, v14, v15
    v_max_f32 v28, 0, v28
    v_max_f32 v29, 0, v29
    v_max_f32 v30, 0, v30
    v_max_f32 v31, 0, v31
    v_pk_mul_f32 v[28:29], v[28:29], v[28:29]
    v_pk_mul_f32 v[30:31], v[30:31], v[30:31]
    v_cvt_pk_bf16_f32 v242, v28, v29
    v_cvt_pk_bf16_f32 v243, v30, v31
    buffer_store_dwordx4 v[240:243], v4, s[44:47], s56 offen offset:1024 sc1
    v_max_f32 v16, 0, v16
    v_max_f32 v17, 0, v17
    v_max_f32 v18, 0, v18
    v_max_f32 v19, 0, v19
    v_pk_mul_f32 v[16:17], v[16:17], v[16:17]
    v_pk_mul_f32 v[18:19], v[18:19], v[18:19]
    v_cvt_pk_bf16_f32 v244, v16, v17
    v_cvt_pk_bf16_f32 v245, v18, v19
    v_max_f32 v32, 0, v32
    v_max_f32 v33, 0, v33
    v_max_f32 v34, 0, v34
    v_max_f32 v35, 0, v35
    v_pk_mul_f32 v[32:33], v[32:33], v[32:33]
    v_pk_mul_f32 v[34:35], v[34:35], v[34:35]
    v_cvt_pk_bf16_f32 v246, v32, v33
    v_cvt_pk_bf16_f32 v247, v34, v35
    buffer_store_dwordx4 v[244:247], v4, s[44:47], s56 offen offset:2048 sc1
    v_max_f32 v20, 0, v20
    v_max_f32 v21, 0, v21
    v_max_f32 v22, 0, v22
    v_max_f32 v23, 0, v23
    v_pk_mul_f32 v[20:21], v[20:21], v[20:21]
    v_pk_mul_f32 v[22:23], v[22:23], v[22:23]
    v_cvt_pk_bf16_f32 v248, v20, v21
    v_cvt_pk_bf16_f32 v249, v22, v23
    v_max_f32 v36, 0, v36
    v_max_f32 v37, 0, v37
    v_max_f32 v38, 0, v38
    v_max_f32 v39, 0, v39
    v_pk_mul_f32 v[36:37], v[36:37], v[36:37]
    v_pk_mul_f32 v[38:39], v[38:39], v[38:39]
    v_cvt_pk_bf16_f32 v250, v36, v37
    v_cvt_pk_bf16_f32 v251, v38, v39
    buffer_store_dwordx4 v[248:251], v4, s[44:47], s56 offen offset:3072 sc1
    s_add_u32 s56, s56, 4096
    v_max_f32 v40, 0, v40
    v_max_f32 v41, 0, v41
    v_max_f32 v42, 0, v42
    v_max_f32 v43, 0, v43
    v_pk_mul_f32 v[40:41], v[40:41], v[40:41]
    v_pk_mul_f32 v[42:43], v[42:43], v[42:43]
    v_cvt_pk_bf16_f32 v236, v40, v41
    v_cvt_pk_bf16_f32 v237, v42, v43
    v_max_f32 v56, 0, v56
    v_max_f32 v57, 0, v57
    v_max_f32 v58, 0, v58
    v_max_f32 v59, 0, v59
    v_pk_mul_f32 v[56:57], v[56:57], v[56:57]
    v_pk_mul_f32 v[58:59], v[58:59], v[58:59]
    v_cvt_pk_bf16_f32 v238, v56, v57
    v_cvt_pk_bf16_f32 v239, v58, v59
    buffer_store_dwordx4 v[236:239], v4, s[44:47], s56 offen offset:0 sc1
    v_max_f32 v44, 0, v44
    v_max_f32 v45, 0, v45
    v_max_f32 v46, 0, v46
    v_max_f32 v47, 0, v47
    v_pk_mul_f32 v[44:45], v[44:45], v[44:45]
    v_pk_mul_f32 v[46:47], v[46:47], v[46:47]
    v_cvt_pk_bf16_f32 v240, v44, v45
    v_cvt_pk_bf16_f32 v241, v46, v47
    v_max_f32 v60, 0, v60
    v_max_f32 v61, 0, v61
    v_max_f32 v62, 0, v62
    v_max_f32 v63, 0, v63
    v_pk_mul_f32 v[60:61], v[60:61], v[60:61]
    v_pk_mul_f32 v[62:63], v[62:63], v[62:63]
    v_cvt_pk_bf16_f32 v242, v60, v61
    v_cvt_pk_bf16_f32 v243, v62, v63
    buffer_store_dwordx4 v[240:243], v4, s[44:47], s56 offen offset:1024 sc1
    v_max_f32 v48, 0, v48
    v_max_f32 v49, 0, v49
    v_max_f32 v50, 0, v50
    v_max_f32 v51, 0, v51
    v_pk_mul_f32 v[48:49], v[48:49], v[48:49]
    v_pk_mul_f32 v[50:51], v[50:51], v[50:51]
    v_cvt_pk_bf16_f32 v244, v48, v49
    v_cvt_pk_bf16_f32 v245, v50, v51
    v_max_f32 v64, 0, v64
    v_max_f32 v65, 0, v65
    v_max_f32 v66, 0, v66
    v_max_f32 v67, 0, v67
    v_pk_mul_f32 v[64:65], v[64:65], v[64:65]
    v_pk_mul_f32 v[66:67], v[66:67], v[66:67]
    v_cvt_pk_bf16_f32 v246, v64, v65
    v_cvt_pk_bf16_f32 v247, v66, v67
    buffer_store_dwordx4 v[244:247], v4, s[44:47], s56 offen offset:2048 sc1
    v_max_f32 v52, 0, v52
    v_max_f32 v53, 0, v53
    v_max_f32 v54, 0, v54
    v_max_f32 v55, 0, v55
    v_pk_mul_f32 v[52:53], v[52:53], v[52:53]
    v_pk_mul_f32 v[54:55], v[54:55], v[54:55]
    v_cvt_pk_bf16_f32 v248, v52, v53
    v_cvt_pk_bf16_f32 v249, v54, v55
    v_max_f32 v68, 0, v68
    v_max_f32 v69, 0, v69
    v_max_f32 v70, 0, v70
    v_max_f32 v71, 0, v71
    v_pk_mul_f32 v[68:69], v[68:69], v[68:69]
    v_pk_mul_f32 v[70:71], v[70:71], v[70:71]
    v_cvt_pk_bf16_f32 v250, v68, v69
    v_cvt_pk_bf16_f32 v251, v70, v71
    buffer_store_dwordx4 v[248:251], v4, s[44:47], s56 offen offset:3072 sc1
    s_add_u32 s56, s56, 4096
    s_cmp_ge_u32 s63, 52
    s_cbranch_scc1 L_epiB_short
    v_max_f32 v72, 0, v72
    v_max_f32 v73, 0, v73
    v_max_f32 v74, 0, v74
    v_max_f32 v75, 0, v75
    v_pk_mul_f32 v[72:73], v[72:73], v[72:73]
    v_pk_mul_f32 v[74:75], v[74:75], v[74:75]
    v_cvt_pk_bf16_f32 v236, v72, v73
    v_cvt_pk_bf16_f32 v237, v74, v75
    v_max_f32 v88, 0, v88
    v_max_f32 v89, 0, v89
    v_max_f32 v90, 0, v90
    v_max_f32 v91, 0, v91
    v_pk_mul_f32 v[88:89], v[88:89], v[88:89]
    v_pk_mul_f32 v[90:91], v[90:91], v[90:91]
    v_cvt_pk_bf16_f32 v238, v88, v89
    v_cvt_pk_bf16_f32 v239, v90, v91
    buffer_store_dwordx4 v[236:239], v4, s[44:47], s56 offen offset:0 sc1
    v_max_f32 v76, 0, v76
    v_max_f32 v77, 0, v77
    v_max_f32 v78, 0, v78
    v_max_f32 v79, 0, v79
    v_pk_mul_f32 v[76:77], v[76:77], v[76:77]
    v_pk_mul_f32 v[78:79], v[78:79], v[78:79]
    v_cvt_pk_bf16_f32 v240, v76, v77
    v_cvt_pk_bf16_f32 v241, v78, v79
    v_max_f32 v92, 0, v92
    v_max_f32 v93, 0, v93
    v_max_f32 v94, 0, v94
    v_max_f32 v95, 0, v95
    v_pk_mul_f32 v[92:93], v[92:93], v[92:93]
    v_pk_mul_f32 v[94:95], v[94:95], v[94:95]
    v_cvt_pk_bf16_f32 v242, v92, v93
    v_cvt_pk_bf16_f32 v243, v94, v95
    buffer_store_dwordx4 v[240:243], v4, s[44:47], s56 offen offset:1024 sc1
    v_max_f32 v80, 0, v80
    v_max_f32 v81, 0, v81
    v_max_f32 v82, 0, v82
    v_max_f32 v83, 0, v83
    v_pk_mul_f32 v[80:81], v[80:81], v[80:81]
    v_pk_mul_f32 v[82:83], v[82:83], v[82:83]
    v_cvt_pk_bf16_f32 v244, v80, v81
    v_cvt_pk_bf16_f32 v245, v82, v83
    v_max_f32 v96, 0, v96
    v_max_f32 v97, 0, v97
    v_max_f32 v98, 0, v98
    v_max_f32 v99, 0, v99
    v_pk_mul_f32 v[96:97], v[96:97], v[96:97]
    v_pk_mul_f32 v[98:99], v[98:99], v[98:99]
    v_cvt_pk_bf16_f32 v246, v96, v97
    v_cvt_pk_bf16_f32 v247, v98, v99
    buffer_store_dwordx4 v[244:247], v4, s[44:47], s56 offen offset:2048 sc1
    v_max_f32 v84, 0, v84
    v_max_f32 v85, 0, v85
    v_max_f32 v86, 0, v86
    v_max_f32 v87, 0, v87
    v_pk_mul_f32 v[84:85], v[84:85], v[84:85]
    v_pk_mul_f32 v[86:87], v[86:87], v[86:87]
    v_cvt_pk_bf16_f32 v248, v84, v85
    v_cvt_pk_bf16_f32 v249, v86, v87
    v_max_f32 v100, 0, v100
    v_max_f32 v101, 0, v101
    v_max_f32 v102, 0, v102
    v_max_f32 v103, 0, v103
    v_pk_mul_f32 v[100:101], v[100:101], v[100:101]
    v_pk_mul_f32 v[102:103], v[102:103], v[102:103]
    v_cvt_pk_bf16_f32 v250, v100, v101
    v_cvt_pk_bf16_f32 v251, v102, v103
    buffer_store_dwordx4 v[248:251], v4, s[44:47], s56 offen offset:3072 sc1
    s_add_u32 s56, s56, 4096
    v_max_f32 v104, 0, v104
    v_max_f32 v105, 0, v105
    v_max_f32 v106, 0, v106
    v_max_f32 v107, 0, v107
    v_pk_mul_f32 v[104:105], v[104:105], v[104:105]
    v_pk_mul_f32 v[106:107], v[106:107], v[106:107]
    v_cvt_pk_bf16_f32 v236, v104, v105
    v_cvt_pk_bf16_f32 v237, v106, v107
    v_max_f32 v120, 0, v120
    v_max_f32 v121, 0, v121
    v_max_f32 v122, 0, v122
    v_max_f32 v123, 0, v123
    v_pk_mul_f32 v[120:121], v[120:121], v[120:121]
    v_pk_mul_f32 v[122:123], v[122:123], v[122:123]
    v_cvt_pk_bf16_f32 v238, v120, v121
    v_cvt_pk_bf16_f32 v239, v122, v123
    buffer_store_dwordx4 v[236:239], v4, s[44:47], s56 offen offset:0 sc1
    v_max_f32 v108, 0, v108
    v_max_f32 v109, 0, v109
    v_max_f32 v110, 0, v110
    v_max_f32 v111, 0, v111
    v_pk_mul_f32 v[108:109], v[108:109], v[108:109]
    v_pk_mul_f32 v[110:111], v[110:111], v[110:111]
    v_cvt_pk_bf16_f32 v240, v108, v109
    v_cvt_pk_bf16_f32 v241, v110, v111
    v_max_f32 v124, 0, v124
    v_max_f32 v125, 0, v125
    v_max_f32 v126, 0, v126
    v_max_f32 v127, 0, v127
    v_pk_mul_f32 v[124:125], v[124:125], v[124:125]
    v_pk_mul_f32 v[126:127], v[126:127], v[126:127]
    v_cvt_pk_bf16_f32 v242, v124, v125
    v_cvt_pk_bf16_f32 v243, v126, v127
    buffer_store_dwordx4 v[240:243], v4, s[44:47], s56 offen offset:1024 sc1
    v_max_f32 v112, 0, v112
    v_max_f32 v113, 0, v113
    v_max_f32 v114, 0, v114
    v_max_f32 v115, 0, v115
    v_pk_mul_f32 v[112:113], v[112:113], v[112:113]
    v_pk_mul_f32 v[114:115], v[114:115], v[114:115]
    v_cvt_pk_bf16_f32 v244, v112, v113
    v_cvt_pk_bf16_f32 v245, v114, v115
    v_max_f32 v128, 0, v128
    v_max_f32 v129, 0, v129
    v_max_f32 v130, 0, v130
    v_max_f32 v131, 0, v131
    v_pk_mul_f32 v[128:129], v[128:129], v[128:129]
    v_pk_mul_f32 v[130:131], v[130:131], v[130:131]
    v_cvt_pk_bf16_f32 v246, v128, v129
    v_cvt_pk_bf16_f32 v247, v130, v131
    buffer_store_dwordx4 v[244:247], v4, s[44:47], s56 offen offset:2048 sc1
    v_max_f32 v116, 0, v116
    v_max_f32 v117, 0, v117
    v_max_f32 v118, 0, v118
    v_max_f32 v119, 0, v119
    v_pk_mul_f32 v[116:117], v[116:117], v[116:117]
    v_pk_mul_f32 v[118:119], v[118:119], v[118:119]
    v_cvt_pk_bf16_f32 v248, v116, v117
    v_cvt_pk_bf16_f32 v249, v118, v119
    v_max_f32 v132, 0, v132
    v_max_f32 v133, 0, v133
    v_max_f32 v134, 0, v134
    v_max_f32 v135, 0, v135
    v_pk_mul_f32 v[132:133], v[132:133], v[132:133]
    v_pk_mul_f32 v[134:135], v[134:135], v[134:135]
    v_cvt_pk_bf16_f32 v250, v132, v133
    v_cvt_pk_bf16_f32 v251, v134, v135
    buffer_store_dwordx4 v[248:251], v4, s[44:47], s56 offen offset:3072 sc1
    s_add_u32 s56, s56, 4096
L_epiB_short:
L_epiB_done:
    s_branch L_cw_pref
L_epiA:
L_epiA_gate:
    s_cmp_eq_u32 s35, 0
    s_cbranch_scc0 L_epiA_w
    v_cvt_pk_bf16_f32 v12, v120, v120
    v_lshlrev_b32 v12, 16, v12
    v_mul_f32 v12, 0xbfb8aa3b, v12
    v_exp_f32 v12, v12
    s_nop 0
    v_add_f32 v12, 1.0, v12
    v_rcp_f32 v12, v12
    s_nop 0
    v_cvt_pk_bf16_f32 v12, v12, v12
    v_lshlrev_b32 v8, 16, v12
    v_cvt_pk_bf16_f32 v12, v124, v124
    v_lshlrev_b32 v12, 16, v12
    v_mul_f32 v12, 0xbfb8aa3b, v12
    v_exp_f32 v12, v12
    s_nop 0
    v_add_f32 v12, 1.0, v12
    v_rcp_f32 v12, v12
    s_nop 0
    v_cvt_pk_bf16_f32 v12, v12, v12
    v_lshlrev_b32 v9, 16, v12
    v_cvt_pk_bf16_f32 v12, v128, v128
    v_lshlrev_b32 v12, 16, v12
    v_mul_f32 v12, 0xbfb8aa3b, v12
    v_exp_f32 v12, v12
    s_nop 0
    v_add_f32 v12, 1.0, v12
    v_rcp_f32 v12, v12
    s_nop 0
    v_cvt_pk_bf16_f32 v12, v12, v12
    v_lshlrev_b32 v10, 16, v12
    v_cvt_pk_bf16_f32 v12, v132, v132
    v_lshlrev_b32 v12, 16, v12
    v_mul_f32 v12, 0xbfb8aa3b, v12
    v_exp_f32 v12, v12
    s_nop 0
    v_add_f32 v12, 1.0, v12
    v_rcp_f32 v12, v12
    s_nop 0
    v_cvt_pk_bf16_f32 v12, v12, v12
    v_lshlrev_b32 v11, 16, v12
    v_and_b32 v233, 15, v1
    v_add_u32 v12, 0, v233
    v_lshlrev_b32 v13, 1, v12
    s_add_u32 s56, s76, s74
    v_add_u32 v13, s56, v13
    v_lshlrev_b32 v14, 2, v13
    v_cmp_le_u32 s[90:91], 7, v12
    v_cmp_gt_u32 s[92:93], 16, v1
    v_cmp_gt_u32 vcc, 2048, v13
    s_nop 2
    s_and_b64 s[90:91], s[90:91], s[92:93]
    s_and_b64 vcc, vcc, s[90:91]
    v_mov_b32 v15, 2147483648
    s_nop 1
    v_cndmask_b32 v14, v15, v14, vcc
    s_mov_b32 s57, 13631488
    buffer_store_dword v8, v14, s[44:47], s57 offen sc1
    v_add_u32 v12, 16, v233
    v_lshlrev_b32 v13, 1, v12
    s_add_u32 s56, s76, s74
    v_add_u32 v13, s56, v13
    v_lshlrev_b32 v14, 2, v13
    v_cmp_le_u32 s[90:91], 7, v12
    v_cmp_gt_u32 s[92:93], 16, v1
    v_cmp_gt_u32 vcc, 2048, v13
    s_nop 2
    s_and_b64 s[90:91], s[90:91], s[92:93]
    s_and_b64 vcc, vcc, s[90:91]
    v_mov_b32 v15, 2147483648
    s_nop 1
    v_cndmask_b32 v14, v15, v14, vcc
    s_mov_b32 s57, 13631488
    buffer_store_dword v9, v14, s[44:47], s57 offen sc1
    v_add_u32 v12, 32, v233
    v_lshlrev_b32 v13, 1, v12
    s_add_u32 s56, s76, s74
    v_add_u32 v13, s56, v13
    v_lshlrev_b32 v14, 2, v13
    v_cmp_le_u32 s[90:91], 7, v12
    v_cmp_gt_u32 s[92:93], 16, v1
    v_cmp_gt_u32 vcc, 2048, v13
    s_nop 2
    s_and_b64 s[90:91], s[90:91], s[92:93]
    s_and_b64 vcc, vcc, s[90:91]
    v_mov_b32 v15, 2147483648
    s_nop 1
    v_cndmask_b32 v14, v15, v14, vcc
    s_mov_b32 s57, 13631488
    buffer_store_dword v10, v14, s[44:47], s57 offen sc1
    v_add_u32 v12, 48, v233
    v_lshlrev_b32 v13, 1, v12
    s_add_u32 s56, s76, s74
    v_add_u32 v13, s56, v13
    v_lshlrev_b32 v14, 2, v13
    v_cmp_le_u32 s[90:91], 7, v12
    v_cmp_gt_u32 s[92:93], 16, v1
    v_cmp_gt_u32 vcc, 2048, v13
    s_nop 2
    s_and_b64 s[90:91], s[90:91], s[92:93]
    s_and_b64 vcc, vcc, s[90:91]
    v_mov_b32 v15, 2147483648
    s_nop 1
    v_cndmask_b32 v14, v15, v14, vcc
    s_mov_b32 s57, 13631488
    buffer_store_dword v11, v14, s[44:47], s57 offen sc1
L_epiA_w:
    s_waitcnt lgkmcnt(0)
L_attn:
    s_barrier
    ds_read_b64 v[16:17], v240 offset:3904
    ds_read_b64 v[18:19], v240 offset:3912
    ds_read_b64 v[20:21], v240 offset:3920
    ds_read_b64 v[22:23], v240 offset:3928
    ds_read_b64 v[24:25], v240 offset:3936
    ds_read_b64 v[28:29], v240 offset:160
    ds_read_b64 v[30:31], v240 offset:168
    ds_read_b64 v[32:33], v240 offset:176
    ds_read_b64 v[34:35], v240 offset:184
    ds_read_b64 v[36:37], v240 offset:192
    ds_read_b64 v[38:39], v240 offset:2112
    ds_read_b64 v[40:41], v240 offset:2120
    ds_read_b64 v[42:43], v240 offset:2128
    ds_read_b64 v[44:45], v240 offset:2136
    ds_read_b64 v[46:47], v240 offset:2144
    ds_read_b64 v[48:49], v240 offset:4064
    ds_read_b64 v[50:51], v240 offset:4072
    ds_read_b64 v[52:53], v240 offset:4080
    ds_read_b64 v[54:55], v240 offset:4088
    ds_read_b64 v[56:57], v240 offset:4096
    ds_read_b64_tr_b16 v[60:61], v241 offset:320
    ds_read_b64_tr_b16 v[62:63], v241 offset:328
    ds_read_b64_tr_b16 v[64:65], v241 offset:336
    ds_read_b64_tr_b16 v[66:67], v241 offset:344
    ds_read_b64_tr_b16 v[68:69], v241 offset:352
    ds_read_b64_tr_b16 v[70:71], v241 offset:2272
    ds_read_b64_tr_b16 v[72:73], v241 offset:2280
    ds_read_b64_tr_b16 v[74:75], v241 offset:2288
    ds_read_b64_tr_b16 v[76:77], v241 offset:2296
    ds_read_b64_tr_b16 v[78:79], v241 offset:2304
    ds_read_b64_tr_b16 v[80:81], v241 offset:4224
    ds_read_b64_tr_b16 v[82:83], v241 offset:4232
    ds_read_b64_tr_b16 v[84:85], v241 offset:4240
    ds_read_b64_tr_b16 v[86:87], v241 offset:4248
    ds_read_b64_tr_b16 v[88:89], v241 offset:4256
    v_lshlrev_b32 v4, 4, v1
    s_cmp_lt_u32 s32, 4
    s_cbranch_scc0 L_sp_3
    s_waitcnt vmcnt(0)
    s_mov_b32 s57, 0x40000
    s_lshl_b32 s58, s64, 1
L_wpl_4:
    v_cmp_gt_u32 s[88:89], s58, v1
    v_cmp_ne_u32 vcc, 1, v255
    s_nop 3
    s_and_b64 vcc, vcc, s[88:89]
    s_cbranch_vccz L_wpk_5
    s_mov_b32 s56, 13713408
    buffer_load_dword v255, v232, s[44:47], s56 offen sc1
    s_waitcnt vmcnt(0)
    s_sub_u32 s57, s57, 1
    s_cmp_lg_u32 s57, 0
    s_cbranch_scc1 L_wpl_4
L_wpk_5:
    s_add_u32 s65, s82, 0
    s_sub_u32 s67, s65, s64
    s_cmp_ge_u32 s65, s64
    s_cselect_b32 s65, s67, s65
    s_mul_i32 s67, s65, 5120
    s_add_u32 s67, s67, s81
    s_add_u32 s68, s67, 4096
    buffer_load_dwordx4 v[136:139], v4, s[44:47], s67 offen offset:0 sc1
    buffer_load_dwordx4 v[140:143], v4, s[44:47], s67 offen offset:1024 sc1
    buffer_load_dwordx4 v[144:147], v4, s[44:47], s67 offen offset:2048 sc1
    buffer_load_dwordx4 v[148:151], v4, s[44:47], s67 offen offset:3072 sc1
    buffer_load_dwordx4 v[152:155], v4, s[44:47], s68 offen sc1
L_sp_3:
    v_mov_b32 v92, 0
    v_mov_b32 v93, 0
    v_mov_b32 v94, 0
    v_mov_b32 v95, 0
    v_mov_b32 v96, 0
    v_mov_b32 v97, 0
    v_mov_b32 v98, 0
    v_mov_b32 v99, 0
    v_mov_b32 v100, 0
    v_mov_b32 v101, 0
    v_mov_b32 v102, 0
    v_mov_b32 v103, 0
    v_mov_b32 v104, 0
    v_mov_b32 v105, 0
    v_mov_b32 v106, 0
    v_mov_b32 v107, 0
    v_mov_b32 v108, 0
    v_mov_b32 v109, 0
    v_mov_b32 v110, 0
    v_mov_b32 v111, 0
    v_mov_b32 v112, 0
    v_mov_b32 v113, 0
    v_mov_b32 v114, 0
    v_mov_b32 v115, 0
    v_mov_b32 v116, 0
    v_mov_b32 v117, 0
    v_mov_b32 v118, 0
    v_mov_b32 v119, 0
    v_mov_b32 v120, 0
    v_mov_b32 v121, 0
    v_mov_b32 v122, 0
    v_mov_b32 v123, 0
    v_and_b32 v9, 3, v1
    v_cmp_eq_u32 s[90:91], 0, v9
    v_cmp_ge_u32 s[92:93], 1, v9
    v_cmp_ge_u32 s[94:95], 2, v9
    s_waitcnt lgkmcnt(15)
    v_mfma_f32_4x4x4_16b_bf16 v[92:95], v[28:29], v[16:17], v[92:95]
    v_mfma_f32_4x4x4_16b_bf16 v[96:99], v[38:39], v[16:17], v[96:99]
    v_mfma_f32_4x4x4_16b_bf16 v[100:103], v[48:49], v[16:17], v[100:103]
    v_mfma_f32_4x4x4_16b_bf16 v[92:95], v[30:31], v[18:19], v[92:95]
    v_mfma_f32_4x4x4_16b_bf16 v[96:99], v[40:41], v[18:19], v[96:99]
    v_mfma_f32_4x4x4_16b_bf16 v[100:103], v[50:51], v[18:19], v[100:103]
    v_mfma_f32_4x4x4_16b_bf16 v[92:95], v[32:33], v[20:21], v[92:95]
    v_mfma_f32_4x4x4_16b_bf16 v[96:99], v[42:43], v[20:21], v[96:99]
    v_mfma_f32_4x4x4_16b_bf16 v[100:103], v[52:53], v[20:21], v[100:103]
    v_mfma_f32_4x4x4_16b_bf16 v[92:95], v[34:35], v[22:23], v[92:95]
    v_mfma_f32_4x4x4_16b_bf16 v[96:99], v[44:45], v[22:23], v[96:99]
    v_mfma_f32_4x4x4_16b_bf16 v[100:103], v[54:55], v[22:23], v[100:103]
    v_mfma_f32_4x4x4_16b_bf16 v[92:95], v[36:37], v[24:25], v[92:95]
    v_mfma_f32_4x4x4_16b_bf16 v[96:99], v[46:47], v[24:25], v[96:99]
    v_mfma_f32_4x4x4_16b_bf16 v[100:103], v[56:57], v[24:25], v[100:103]
    s_cmp_lt_u32 s32, 4
    s_cbranch_scc0 L_sp_6
    s_add_u32 s65, s82, 1
    s_sub_u32 s67, s65, s64
    s_cmp_ge_u32 s65, s64
    s_cselect_b32 s65, s67, s65
    s_mul_i32 s67, s65, 5120
    s_add_u32 s67, s67, s81
    s_add_u32 s68, s67, 4096
    buffer_load_dwordx4 v[156:159], v4, s[44:47], s67 offen offset:0 sc1
    buffer_load_dwordx4 v[160:163], v4, s[44:47], s67 offen offset:1024 sc1
    buffer_load_dwordx4 v[164:167], v4, s[44:47], s67 offen offset:2048 sc1
    buffer_load_dwordx4 v[168:171], v4, s[44:47], s67 offen offset:3072 sc1
    buffer_load_dwordx4 v[172:175], v4, s[44:47], s68 offen sc1
L_sp_6:
    s_nop 4
    v_cndmask_b32 v124, v101, v93, s[90:91]
    v_cndmask_b32 v125, v102, v94, s[92:93]
    v_cndmask_b32 v126, v103, v95, s[94:95]
    s_cmp_eq_u32 s34, 0
    s_cbranch_scc0 L_nomask
    v_and_b32 v9, 60, v1
    v_sub_u32 v9, 15, v9
    v_mov_b32 v10, 0xf149f2ca
    v_cmp_lt_i32 vcc, 4, v9
    s_nop 1
    v_cndmask_b32 v96, v96, v10, vcc
    v_cmp_lt_i32 vcc, 5, v9
    s_nop 1
    v_cndmask_b32 v97, v97, v10, vcc
    v_cmp_lt_i32 vcc, 6, v9
    s_nop 1
    v_cndmask_b32 v98, v98, v10, vcc
    v_cmp_lt_i32 vcc, 7, v9
    s_nop 1
    v_cndmask_b32 v99, v99, v10, vcc
    v_cmp_lt_i32 vcc, 8, v9
    s_nop 1
    v_cndmask_b32 v100, v100, v10, vcc
    v_mov_b32 v11, 9
    v_cndmask_b32 v11, v11, 1, s[90:91]
    v_cmp_lt_i32 vcc, v11, v9
    s_nop 1
    v_cndmask_b32 v124, v124, v10, vcc
    v_mov_b32 v11, 10
    v_cndmask_b32 v11, v11, 2, s[92:93]
    v_cmp_lt_i32 vcc, v11, v9
    s_nop 1
    v_cndmask_b32 v125, v125, v10, vcc
    v_mov_b32 v11, 11
    v_cndmask_b32 v11, v11, 3, s[94:95]
    v_cmp_lt_i32 vcc, v11, v9
    s_nop 1
    v_cndmask_b32 v126, v126, v10, vcc
L_nomask:
    v_max3_f32 v9, v124, v125, v126
    v_max3_f32 v10, v96, v97, v98
    v_max3_f32 v9, v9, v99, v100
    v_max_f32 v9, v9, v10
    s_mov_b32 s60, 1051011932
    v_mul_f32 v9, s60, v9
    v_fma_f32 v124, v124, s60, -v9
    v_fma_f32 v125, v125, s60, -v9
    v_fma_f32 v126, v126, s60, -v9
    v_fma_f32 v96, v96, s60, -v9
    v_fma_f32 v97, v97, s60, -v9
    v_fma_f32 v98, v98, s60, -v9
    v_fma_f32 v99, v99, s60, -v9
    v_fma_f32 v100, v100, s60, -v9
    v_exp_f32 v124, v124
    v_exp_f32 v125, v125
    v_exp_f32 v126, v126
    v_exp_f32 v96, v96
    v_exp_f32 v97, v97
    v_exp_f32 v98, v98
    v_exp_f32 v99, v99
    v_exp_f32 v100, v100
    v_add_f32 v9, v124, v125
    v_add_f32 v10, v126, v96
    v_add_f32 v11, v97, v98
    v_add_f32 v12, v99, v100
    v_add_f32 v9, v9, v10
    v_add_f32 v11, v11, v12
    v_add_f32 v9, v9, v11
    v_rcp_f32 v9, v9
    s_nop 0
    v_mul_f32 v124, v124, v9
    v_mul_f32 v125, v125, v9
    v_mul_f32 v126, v126, v9
    v_mul_f32 v96, v96, v9
    v_mul_f32 v97, v97, v9
    v_mul_f32 v98, v98, v9
    v_mul_f32 v99, v99, v9
    v_mul_f32 v100, v100, v9
    v_cndmask_b32 v93, 0, v124, s[90:91]
    v_cndmask_b32 v101, v124, 0, s[90:91]
    v_cndmask_b32 v94, 0, v125, s[92:93]
    v_cndmask_b32 v102, v125, 0, s[92:93]
    v_cndmask_b32 v95, 0, v126, s[94:95]
    v_cndmask_b32 v103, v126, 0, s[94:95]
    v_mov_b32 v92, 0
    v_cvt_pk_bf16_f32 v128, v92, v93
    v_cvt_pk_bf16_f32 v129, v94, v95
    v_cvt_pk_bf16_f32 v130, v96, v97
    v_cvt_pk_bf16_f32 v131, v98, v99
    v_cvt_pk_bf16_f32 v132, v100, v101
    v_cvt_pk_bf16_f32 v133, v102, v103
    s_cmp_lt_u32 s32, 4
    s_cbranch_scc0 L_sp_7
    s_add_u32 s65, s82, 2
    s_sub_u32 s67, s65, s64
    s_cmp_ge_u32 s65, s64
    s_cselect_b32 s65, s67, s65
    s_mul_i32 s67, s65, 5120
    s_add_u32 s67, s67, s81
    s_add_u32 s68, s67, 4096
    buffer_load_dwordx4 v[176:179], v4, s[44:47], s67 offen offset:0 sc1
    buffer_load_dwordx4 v[180:183], v4, s[44:47], s67 offen offset:1024 sc1
    buffer_load_dwordx4 v[184:187], v4, s[44:47], s67 offen offset:2048 sc1
    buffer_load_dwordx4 v[188:191], v4, s[44:47], s67 offen offset:3072 sc1
    buffer_load_dwordx4 v[192:195], v4, s[44:47], s68 offen sc1
L_sp_7:
    s_waitcnt lgkmcnt(0)
    v_mfma_f32_4x4x4_16b_bf16 v[104:107], v[60:61], v[128:129], v[104:107]
    v_mfma_f32_4x4x4_16b_bf16 v[108:111], v[62:63], v[128:129], v[108:111]
    v_mfma_f32_4x4x4_16b_bf16 v[112:115], v[64:65], v[128:129], v[112:115]
    v_mfma_f32_4x4x4_16b_bf16 v[116:119], v[66:67], v[128:129], v[116:119]
    v_mfma_f32_4x4x4_16b_bf16 v[120:123], v[68:69], v[128:129], v[120:123]
    v_mfma_f32_4x4x4_16b_bf16 v[104:107], v[70:71], v[130:131], v[104:107]
    v_mfma_f32_4x4x4_16b_bf16 v[108:111], v[72:73], v[130:131], v[108:111]
    v_mfma_f32_4x4x4_16b_bf16 v[112:115], v[74:75], v[130:131], v[112:115]
    v_mfma_f32_4x4x4_16b_bf16 v[116:119], v[76:77], v[130:131], v[116:119]
    v_mfma_f32_4x4x4_16b_bf16 v[120:123], v[78:79], v[130:131], v[120:123]
    v_mfma_f32_4x4x4_16b_bf16 v[104:107], v[80:81], v[132:133], v[104:107]
    v_mfma_f32_4x4x4_16b_bf16 v[108:111], v[82:83], v[132:133], v[108:111]
    v_mfma_f32_4x4x4_16b_bf16 v[112:115], v[84:85], v[132:133], v[112:115]
    v_mfma_f32_4x4x4_16b_bf16 v[116:119], v[86:87], v[132:133], v[116:119]
    v_mfma_f32_4x4x4_16b_bf16 v[120:123], v[88:89], v[132:133], v[120:123]
    s_nop 0
    v_cvt_pk_bf16_f32 v16, v104, v105
    v_cvt_pk_bf16_f32 v17, v106, v107
    ds_write_b64 v242, v[16:17] offset:0
    v_cvt_pk_bf16_f32 v18, v108, v109
    v_cvt_pk_bf16_f32 v19, v110, v111
    ds_write_b64 v242, v[18:19] offset:8
    v_cvt_pk_bf16_f32 v20, v112, v113
    v_cvt_pk_bf16_f32 v21, v114, v115
    ds_write_b64 v242, v[20:21] offset:16
    v_cvt_pk_bf16_f32 v22, v116, v117
    v_cvt_pk_bf16_f32 v23, v118, v119
    ds_write_b64 v242, v[22:23] offset:24
    v_cvt_pk_bf16_f32 v24, v120, v121
    v_cvt_pk_bf16_f32 v25, v122, v123
    ds_write_b64 v242, v[24:25] offset:32
    s_cmp_lt_u32 s32, 4
    s_cbranch_scc0 L_sp_8
    s_add_u32 s65, s82, 3
    s_sub_u32 s67, s65, s64
    s_cmp_ge_u32 s65, s64
    s_cselect_b32 s65, s67, s65
    s_mul_i32 s67, s65, 5120
    s_add_u32 s67, s67, s81
    s_add_u32 s68, s67, 4096
    buffer_load_dwordx4 v[196:199], v4, s[44:47], s67 offen offset:0 sc1
    buffer_load_dwordx4 v[200:203], v4, s[44:47], s67 offen offset:1024 sc1
    buffer_load_dwordx4 v[204:207], v4, s[44:47], s67 offen offset:2048 sc1
    buffer_load_dwordx4 v[208:211], v4, s[44:47], s67 offen offset:3072 sc1
    buffer_load_dwordx4 v[212:215], v4, s[44:47], s68 offen sc1
L_sp_8:
    s_waitcnt lgkmcnt(0)
    s_barrier
    ds_read_b128 v[8:11], v243
    ds_read_b128 v[12:15], v245
    ds_read_b128 v[16:19], v247
    s_waitcnt lgkmcnt(2)
    buffer_store_dwordx4 v[8:11], v244, s[44:47], s71 offen sc1
    s_waitcnt lgkmcnt(1)
    buffer_store_dwordx4 v[12:15], v246, s[44:47], s72 offen sc1
    s_cmp_ge_u32 s32, 4
    s_cbranch_scc1 L_ostore_done
    s_waitcnt lgkmcnt(0)
    buffer_store_dwordx4 v[16:19], v248, s[44:47], s73 offen sc1
L_ostore_done:
    s_cmp_ge_u32 s32, 4
    s_cbranch_scc0 L_cw_pref
    s_waitcnt vmcnt(0)
    s_branch L_bar3
L_cw_pref:
    s_waitcnt vmcnt(0)
L_bar3:
    s_barrier
    s_cmp_eq_u32 s32, 0
    s_cbranch_scc0 L_flag_done
    s_lshl_b32 s56, s84, 6
    s_add_u32 s56, s56, 13697024
    v_mov_b32 v2, 0
    v_mov_b32 v3, 1
    s_mov_b64 s[88:89], exec
    s_mov_b64 exec, 1
    buffer_store_dword v3, v2, s[44:47], s56 offen sc1
    s_mov_b64 exec, s[88:89]
L_flag_done:
    s_cmp_lt_u32 s32, 4
    s_cbranch_scc0 L_nowp_9
    s_mov_b32 s57, 0x40000
    s_lshl_b32 s58, s64, 1
L_wpl_10:
    v_cmp_gt_u32 s[88:89], s58, v1
    v_cmp_ne_u32 vcc, 1, v255
    s_nop 3
    s_and_b64 vcc, vcc, s[88:89]
    s_cbranch_vccz L_wpk_11
    s_mov_b32 s56, 13713408
    buffer_load_dword v255, v232, s[44:47], s56 offen sc1
    s_waitcnt vmcnt(0)
    s_sub_u32 s57, s57, 1
    s_cmp_lg_u32 s57, 0
    s_cbranch_scc1 L_wpl_10
L_wpk_11:
L_nowp_9:
    s_branch L_phase3
L_ldx:
    s_and_b32 s100, s2, 1
    s_bfe_u32 s101, s2, 0x20001
    s_lshr_b32 s85, s2, 3
    s_cmp_lt_u32 s85, 18
    s_cselect_b32 s33, 1, 0
    s_cbranch_scc0 L_role_bx
    s_mul_i32 s34, s100, 9
    s_lshr_b32 s58, s85, 1
    s_add_u32 s34, s34, s58
    s_lshl_b32 s35, s101, 1
    s_and_b32 s58, s85, 1
    s_add_u32 s35, s35, s58
    s_branch L_role_donex
L_role_bx:
    s_mul_i32 s58, s101, 14
    s_add_u32 s58, s58, s85
    s_sub_u32 s58, s58, 18
    s_lshr_b32 s35, s58, 3
    s_and_b32 s58, s58, 7
    s_lshl_b32 s34, s100, 3
    s_add_u32 s34, s34, s58
L_role_donex:
    s_mul_i32 s58, s100, 9
    s_lshl_b32 s59, s100, 3
    s_cmp_eq_u32 s33, 1
    s_cselect_b32 s58, s58, s59
    s_sub_u32 s3, s34, s58
    s_and_b32 s58, s35, 1
    s_mul_i32 s58, s58, 5
    s_add_u32 s3, s3, s58
    s_cmp_eq_u32 s33, 1
    s_cselect_b32 s58, 0, 2
    s_add_u32 s3, s3, s58
    s_mul_i32 s58, s3, 205
    s_lshr_b32 s58, s58, 11
    s_mul_i32 s58, s58, 10
    s_sub_u32 s3, s3, s58
    s_and_b32 s56, s2, 7
    s_lshr_b32 s57, s2, 3
    s_lshl_b32 s78, s56, 2
    s_lshr_b32 s58, s57, 3
    s_add_u32 s78, s78, s58
    s_and_b32 s79, s57, 7
    s_and_b32 s83, s35, 1
    s_mul_i32 s76, s34, 114
    s_sub_u32 s76, s76, 14
    s_cmp_eq_u32 s33, 1
    s_mov_b32 s77, 3456
    s_cselect_b32 s77, 3840, s77
    s_lshl_b32 s58, s34, 3
    s_add_u32 s58, s58, s35
    s_mul_i32 s59, s34, 7
    s_add_u32 s59, s59, s35
    s_add_u32 s59, s59, 144
    s_cmp_eq_u32 s33, 1
    s_cselect_b32 s84, s58, s59
    v_lshrrev_b32 v2, 3, v1
    v_and_b32 v3, 7, v1
    v_lshrrev_b32 v4, 1, v2
    v_xor_b32 v3, v3, v4
    v_lshlrev_b32 v3, 4, v3
    v_xor_b32 v4, 64, v3
    v_lshlrev_b32 v2, s33, v2
    s_lshl_b32 s56, s34, 7
    s_cmp_eq_u32 s33, 1
    s_cselect_b32 s56, s76, s56
    s_lshl_b32 s57, 8, s33
    s_movk_i32 s59, 2047
    s_movk_i32 s60, 1280
    s_lshl_b32 s65, s3, 7
    v_add_u32 v5, s56, v2
    s_add_u32 s56, s56, s57
    v_med3_i32 v5, v5, 0, s59
    v_mad_u32_u24 v8, v5, s60, v3
    v_add_u32 v5, s56, v2
    s_add_u32 s56, s56, s57
    v_med3_i32 v5, v5, 0, s59
    v_mad_u32_u24 v9, v5, s60, v4
    v_add_u32 v5, s56, v2
    s_add_u32 s56, s56, s57
    v_med3_i32 v5, v5, 0, s59
    v_mad_u32_u24 v10, v5, s60, v3
    v_add_u32 v5, s56, v2
    s_add_u32 s56, s56, s57
    v_med3_i32 v5, v5, 0, s59
    v_mad_u32_u24 v11, v5, s60, v4
    v_add_u32 v5, s56, v2
    s_add_u32 s56, s56, s57
    v_med3_i32 v5, v5, 0, s59
    v_mad_u32_u24 v12, v5, s60, v3
    v_add_u32 v5, s56, v2
    s_add_u32 s56, s56, s57
    v_med3_i32 v5, v5, 0, s59
    v_mad_u32_u24 v13, v5, s60, v4
    v_add_u32 v5, s56, v2
    s_add_u32 s56, s56, s57
    v_med3_i32 v5, v5, 0, s59
    v_mad_u32_u24 v14, v5, s60, v3
    v_add_u32 v5, s56, v2
    s_add_u32 s56, s56, s57
    v_med3_i32 v5, v5, 0, s59
    v_mad_u32_u24 v15, v5, s60, v4
    s_add_u32 s58, s76, 1
    s_cmp_eq_u32 s33, 1
    s_cselect_b32 s56, s58, s56
    v_add_u32 v5, s56, v2
    s_add_u32 s56, s56, s57
    v_med3_i32 v5, v5, 0, s59
    v_mad_u32_u24 v16, v5, s60, v3
    v_add_u32 v5, s56, v2
    s_add_u32 s56, s56, s57
    v_med3_i32 v5, v5, 0, s59
    v_mad_u32_u24 v17, v5, s60, v4
    v_add_u32 v5, s56, v2
    s_add_u32 s56, s56, s57
    v_med3_i32 v5, v5, 0, s59
    v_mad_u32_u24 v18, v5, s60, v3
    v_add_u32 v5, s56, v2
    s_add_u32 s56, s56, s57
    v_med3_i32 v5, v5, 0, s59
    v_mad_u32_u24 v19, v5, s60, v4
    v_add_u32 v5, s56, v2
    s_add_u32 s56, s56, s57
    v_med3_i32 v5, v5, 0, s59
    v_mad_u32_u24 v20, v5, s60, v3
    v_add_u32 v5, s56, v2
    s_add_u32 s56, s56, s57
    v_med3_i32 v5, v5, 0, s59
    v_mad_u32_u24 v21, v5, s60, v4
    v_add_u32 v5, s56, v2
    s_add_u32 s56, s56, s57
    v_med3_i32 v5, v5, 0, s59
    v_mad_u32_u24 v22, v5, s60, v3
    v_add_u32 v5, s56, v2
    s_add_u32 s56, s56, s57
    v_med3_i32 v5, v5, 0, s59
    v_mad_u32_u24 v23, v5, s60, v4
    s_waitcnt lgkmcnt(0)
    s_mov_b32 s36, s8
    s_and_b32 s37, s9, 0xffff
    s_mov_b32 s38, 2621440
    s_mov_b32 s39, 0x20000
    s_cmp_eq_u32 s33, 1
    s_cselect_b32 s40, s10, s16
    s_cselect_b32 s56, s11, s17
    s_mov_b32 s42, 2211840
    s_cselect_b32 s42, 2457600, s42
    s_and_b32 s41, s56, 0xffff
    s_mov_b32 s43, 0x20000
    s_mov_b32 s44, s30
    s_and_b32 s45, s31, 0xffff
    s_mov_b32 s46, 14680064
    s_mov_b32 s47, 0x20000
    s_mov_b32 s96, s28
    s_and_b32 s97, s29, 0xffff
    s_mov_b32 s98, 256
    s_mov_b32 s99, 0x20000
    s_movk_i32 s60, 1280
    s_mov_b32 m0, 0
    s_nop 0
    buffer_load_dwordx4 v8, s[36:39], s65 offen  lds
    s_mov_b32 m0, 1024
    s_nop 0
    buffer_load_dwordx4 v9, s[36:39], s65 offen  lds
    s_mov_b32 m0, 2048
    s_nop 0
    buffer_load_dwordx4 v10, s[36:39], s65 offen  lds
    s_mov_b32 m0, 3072
    s_nop 0
    buffer_load_dwordx4 v11, s[36:39], s65 offen  lds
    s_mov_b32 m0, 4096
    s_nop 0
    buffer_load_dwordx4 v12, s[36:39], s65 offen  lds
    s_mov_b32 m0, 5120
    s_nop 0
    buffer_load_dwordx4 v13, s[36:39], s65 offen  lds
    s_mov_b32 m0, 6144
    s_nop 0
    buffer_load_dwordx4 v14, s[36:39], s65 offen  lds
    s_mov_b32 m0, 7168
    s_nop 0
    buffer_load_dwordx4 v15, s[36:39], s65 offen  lds
    s_mov_b32 m0, 8192
    s_nop 0
    buffer_load_dwordx4 v16, s[36:39], s65 offen  lds
    s_mov_b32 m0, 9216
    s_nop 0
    buffer_load_dwordx4 v17, s[36:39], s65 offen  lds
    s_mov_b32 m0, 10240
    s_nop 0
    buffer_load_dwordx4 v18, s[36:39], s65 offen  lds
    s_mov_b32 m0, 11264
    s_nop 0
    buffer_load_dwordx4 v19, s[36:39], s65 offen  lds
    s_mov_b32 m0, 12288
    s_nop 0
    buffer_load_dwordx4 v20, s[36:39], s65 offen  lds
    s_mov_b32 m0, 13312
    s_nop 0
    buffer_load_dwordx4 v21, s[36:39], s65 offen  lds
    s_mov_b32 m0, 14336
    s_nop 0
    buffer_load_dwordx4 v22, s[36:39], s65 offen  lds
    s_mov_b32 m0, 15360
    s_nop 0
    buffer_load_dwordx4 v23, s[36:39], s65 offen  lds
    s_add_u32 s65, s65, 128
    s_cmp_eq_u32 s65, s60
    s_cselect_b32 s65, 0, s65
    s_mov_b32 m0, 16384
    s_nop 0
    buffer_load_dwordx4 v8, s[36:39], s65 offen  lds
    s_mov_b32 m0, 17408
    s_nop 0
    buffer_load_dwordx4 v9, s[36:39], s65 offen  lds
    s_mov_b32 m0, 18432
    s_nop 0
    buffer_load_dwordx4 v10, s[36:39], s65 offen  lds
    s_mov_b32 m0, 19456
    s_nop 0
    buffer_load_dwordx4 v11, s[36:39], s65 offen  lds
    s_mov_b32 m0, 20480
    s_nop 0
    buffer_load_dwordx4 v12, s[36:39], s65 offen  lds
    s_mov_b32 m0, 21504
    s_nop 0
    buffer_load_dwordx4 v13, s[36:39], s65 offen  lds
    s_mov_b32 m0, 22528
    s_nop 0
    buffer_load_dwordx4 v14, s[36:39], s65 offen  lds
    s_mov_b32 m0, 23552
    s_nop 0
    buffer_load_dwordx4 v15, s[36:39], s65 offen  lds
    s_mov_b32 m0, 24576
    s_nop 0
    buffer_load_dwordx4 v16, s[36:39], s65 offen  lds
    s_mov_b32 m0, 25600
    s_nop 0
    buffer_load_dwordx4 v17, s[36:39], s65 offen  lds
    s_mov_b32 m0, 26624
    s_nop 0
    buffer_load_dwordx4 v18, s[36:39], s65 offen  lds
    s_mov_b32 m0, 27648
    s_nop 0
    buffer_load_dwordx4 v19, s[36:39], s65 offen  lds
    s_mov_b32 m0, 28672
    s_nop 0
    buffer_load_dwordx4 v20, s[36:39], s65 offen  lds
    s_mov_b32 m0, 29696
    s_nop 0
    buffer_load_dwordx4 v21, s[36:39], s65 offen  lds
    s_mov_b32 m0, 30720
    s_nop 0
    buffer_load_dwordx4 v22, s[36:39], s65 offen  lds
    s_mov_b32 m0, 31744
    s_nop 0
    buffer_load_dwordx4 v23, s[36:39], s65 offen  lds
    s_cmp_lt_u32 s32, 2
    s_cbranch_scc1 L_p3o_12
    s_add_u32 s56, s32, 2
    s_sub_u32 s57, s32, 4
    s_cmp_ge_u32 s32, 4
    s_cselect_b32 s56, s57, s56
    s_mul_i32 s58, s56, 9
    s_mul_i32 s80, s78, 54
    s_add_u32 s80, s80, s58
    s_lshl_b32 s80, s80, 12
    s_add_u32 s59, s58, 20
    s_mov_b32 s64, 9
    s_mov_b32 s62, 2147483648
    s_branch L_p3d_13
L_p3o_12:
    s_mul_i32 s59, s32, 10
    s_mul_i32 s80, s78, 20
    s_add_u32 s80, s80, s59
    s_lshl_b32 s80, s80, 12
    s_add_u32 s80, s80, 7340032
    s_mov_b32 s64, 10
    s_mov_b32 s62, 0
L_p3d_13:
    s_mul_i32 s81, s79, 74
    s_add_u32 s81, s81, s59
    s_mul_i32 s81, s81, 5120
    s_add_u32 s81, s81, 10485760
    s_mov_b32 s82, s79
    s_sub_u32 s60, s82, s64
    s_cmp_ge_u32 s82, s64
    s_cselect_b32 s82, s60, s82
    v_lshrrev_b32 v6, 1, v1
    v_add_u32 v6, s59, v6
    v_mul_u32_u24 v6, 10, v6
    s_mul_i32 s60, s79, 5
    s_lshr_b32 s60, s60, 2
    v_and_b32 v7, 1, v1
    v_add_u32 v6, v6, v7
    v_add_u32 v6, s60, v6
    v_mul_u32_u24 v7, 16384, v6
    v_lshrrev_b32 v7, 16, v7
    v_cmp_gt_u32 vcc, 448, v6
    v_subrev_u32 v6, 448, v6
    v_and_b32 v6, 0x3ff, v6
    v_mul_u32_u24 v6, 21846, v6
    v_lshrrev_b32 v6, 16, v6
    v_add_u32 v6, 112, v6
    v_cndmask_b32 v6, v6, v7, vcc
    v_lshlrev_b32 v6, 6, v6
    s_lshl_b32 s60, s64, 1
    v_cmp_gt_u32 vcc, s60, v1
    v_mov_b32 v7, 2147483648
    s_nop 0
    v_cndmask_b32 v232, v7, v6, vcc
    s_cmp_eq_u32 s33, 1
    s_cbranch_scc0 L_aa_14
    s_and_b32 s56, s32, 3
    s_lshr_b32 s57, s32, 2
    s_mul_i32 s58, s57, 31232
    s_mul_i32 s59, s56, 40
    s_add_u32 s58, s58, s59
    s_add_u32 s58, s58, 28864
    v_mul_u32_u24 v240, 488, v1
    v_add_u32 v240, s58, v240
    v_and_b32 v60, 48, v1
    v_and_b32 v61, 3, v1
    v_lshl_add_u32 v60, v61, 2, v60
    v_bfe_u32 v61, v1, 2, 2
    v_add_u32 v60, v60, v61
    v_mul_u32_u24 v241, 488, v60
    v_add_u32 v241, s58, v241
    s_mul_i32 s58, s57, 11264
    s_add_u32 s58, s58, s59
    s_add_u32 s58, s58, 133120
    v_mul_u32_u24 v242, 176, v1
    v_add_u32 v242, s58, v242
    s_add_u32 s56, s32, 0
    s_lshr_b32 s57, s56, 1
    s_and_b32 s56, s56, 1
    s_lshl_b32 s58, s56, 6
    v_add_u32 v60, s58, v1
    v_add_u32 v61, 14, v60
    v_and_b32 v62, 1, v61
    v_lshrrev_b32 v63, 1, v61
    v_lshl_add_u32 v62, v62, 6, v63
    v_min_u32 v62, 127, v62
    v_mul_u32_u24 v62, 176, v62
    s_lshl_b32 s59, s57, 4
    s_add_u32 s59, s59, 133120
    v_add_u32 v243, s59, v62
    s_add_u32 s59, s76, 14
    v_add_u32 v63, s59, v60
    s_mul_i32 s60, s35, 10
    s_add_u32 s60, s60, s57
    s_lshr_b32 s61, s60, 2
    s_and_b32 s60, s60, 3
    s_lshl_b32 s61, s61, 12
    s_lshl_b32 s60, s60, 8
    s_add_u32 s61, s61, s60
    s_add_u32 s71, s61, 7340032
    v_lshrrev_b32 v64, 6, v63
    v_mul_u32_u24 v64, 81920, v64
    v_bfe_u32 v65, v63, 4, 2
    v_lshl_add_u32 v64, v65, 10, v64
    v_and_b32 v65, 15, v63
    v_lshl_add_u32 v64, v65, 4, v64
    v_cmp_gt_u32 vcc, 114, v60
    s_nop 3
    s_mov_b64 s[88:89], vcc
    v_cmp_gt_u32 vcc, 2048, v63
    s_nop 3
    s_and_b64 vcc, vcc, s[88:89]
    v_mov_b32 v65, 2147483648
    s_nop 1
    v_cndmask_b32 v244, v65, v64, vcc
    s_add_u32 s56, s32, 8
    s_lshr_b32 s57, s56, 1
    s_and_b32 s56, s56, 1
    s_lshl_b32 s58, s56, 6
    v_add_u32 v60, s58, v1
    v_add_u32 v61, 14, v60
    v_and_b32 v62, 1, v61
    v_lshrrev_b32 v63, 1, v61
    v_lshl_add_u32 v62, v62, 6, v63
    v_min_u32 v62, 127, v62
    v_mul_u32_u24 v62, 176, v62
    s_lshl_b32 s59, s57, 4
    s_add_u32 s59, s59, 133120
    v_add_u32 v245, s59, v62
    s_add_u32 s59, s76, 14
    v_add_u32 v63, s59, v60
    s_mul_i32 s60, s35, 10
    s_add_u32 s60, s60, s57
    s_lshr_b32 s61, s60, 2
    s_and_b32 s60, s60, 3
    s_lshl_b32 s61, s61, 12
    s_lshl_b32 s60, s60, 8
    s_add_u32 s61, s61, s60
    s_add_u32 s72, s61, 7340032
    v_lshrrev_b32 v64, 6, v63
    v_mul_u32_u24 v64, 81920, v64
    v_bfe_u32 v65, v63, 4, 2
    v_lshl_add_u32 v64, v65, 10, v64
    v_and_b32 v65, 15, v63
    v_lshl_add_u32 v64, v65, 4, v64
    v_cmp_gt_u32 vcc, 114, v60
    s_nop 3
    s_mov_b64 s[88:89], vcc
    v_cmp_gt_u32 vcc, 2048, v63
    s_nop 3
    s_and_b64 vcc, vcc, s[88:89]
    v_mov_b32 v65, 2147483648
    s_nop 1
    v_cndmask_b32 v246, v65, v64, vcc
    s_add_u32 s56, s32, 16
    s_lshr_b32 s57, s56, 1
    s_and_b32 s56, s56, 1
    s_lshl_b32 s58, s56, 6
    v_add_u32 v60, s58, v1
    v_add_u32 v61, 14, v60
    v_and_b32 v62, 1, v61
    v_lshrrev_b32 v63, 1, v61
    v_lshl_add_u32 v62, v62, 6, v63
    v_min_u32 v62, 127, v62
    v_mul_u32_u24 v62, 176, v62
    s_lshl_b32 s59, s57, 4
    s_add_u32 s59, s59, 133120
    v_add_u32 v247, s59, v62
    s_add_u32 s59, s76, 14
    v_add_u32 v63, s59, v60
    s_mul_i32 s60, s35, 10
    s_add_u32 s60, s60, s57
    s_lshr_b32 s61, s60, 2
    s_and_b32 s60, s60, 3
    s_lshl_b32 s61, s61, 12
    s_lshl_b32 s60, s60, 8
    s_add_u32 s61, s61, s60
    s_add_u32 s73, s61, 7340032
    v_lshrrev_b32 v64, 6, v63
    v_mul_u32_u24 v64, 81920, v64
    v_bfe_u32 v65, v63, 4, 2
    v_lshl_add_u32 v64, v65, 10, v64
    v_and_b32 v65, 15, v63
    v_lshl_add_u32 v64, v65, 4, v64
    v_cmp_gt_u32 vcc, 114, v60
    s_nop 3
    s_mov_b64 s[88:89], vcc
    v_cmp_gt_u32 vcc, 2048, v63
    s_nop 3
    s_and_b64 vcc, vcc, s[88:89]
    v_mov_b32 v65, 2147483648
    s_nop 1
    v_cndmask_b32 v248, v65, v64, vcc
L_aa_14:
    s_movk_i32 s60, 1280
    s_waitcnt vmcnt(16)
    s_barrier
    s_add_u32 s65, s65, 128
    s_cmp_eq_u32 s65, s60
    s_cselect_b32 s65, 0, s65
    s_mov_b32 m0, 32768
    s_nop 0
    buffer_load_dwordx4 v8, s[36:39], s65 offen  lds
    s_mov_b32 m0, 33792
    s_nop 0
    buffer_load_dwordx4 v9, s[36:39], s65 offen  lds
    s_mov_b32 m0, 34816
    s_nop 0
    buffer_load_dwordx4 v10, s[36:39], s65 offen  lds
    s_mov_b32 m0, 35840
    s_nop 0
    buffer_load_dwordx4 v11, s[36:39], s65 offen  lds
    s_mov_b32 m0, 36864
    s_nop 0
    buffer_load_dwordx4 v12, s[36:39], s65 offen  lds
    s_mov_b32 m0, 37888
    s_nop 0
    buffer_load_dwordx4 v13, s[36:39], s65 offen  lds
    s_mov_b32 m0, 38912
    s_nop 0
    buffer_load_dwordx4 v14, s[36:39], s65 offen  lds
    s_mov_b32 m0, 39936
    s_nop 0
    buffer_load_dwordx4 v15, s[36:39], s65 offen  lds
    s_mov_b32 m0, 40960
    s_nop 0
    buffer_load_dwordx4 v16, s[36:39], s65 offen  lds
    s_mov_b32 m0, 41984
    s_nop 0
    buffer_load_dwordx4 v17, s[36:39], s65 offen  lds
    s_mov_b32 m0, 43008
    s_nop 0
    buffer_load_dwordx4 v18, s[36:39], s65 offen  lds
    s_mov_b32 m0, 44032
    s_nop 0
    buffer_load_dwordx4 v19, s[36:39], s65 offen  lds
    s_mov_b32 m0, 45056
    s_nop 0
    buffer_load_dwordx4 v20, s[36:39], s65 offen  lds
    s_mov_b32 m0, 46080
    s_nop 0
    buffer_load_dwordx4 v21, s[36:39], s65 offen  lds
    s_mov_b32 m0, 47104
    s_nop 0
    buffer_load_dwordx4 v22, s[36:39], s65 offen  lds
    s_mov_b32 m0, 48128
    s_nop 0
    buffer_load_dwordx4 v23, s[36:39], s65 offen  lds
    s_barrier
    s_add_u32 s65, s65, 128
    s_cmp_eq_u32 s65, s60
    s_cselect_b32 s65, 0, s65
    s_mov_b32 m0, 49152
    s_nop 0
    buffer_load_dwordx4 v8, s[36:39], s65 offen  lds
    s_mov_b32 m0, 50176
    s_nop 0
    buffer_load_dwordx4 v9, s[36:39], s65 offen  lds
    s_mov_b32 m0, 51200
    s_nop 0
    buffer_load_dwordx4 v10, s[36:39], s65 offen  lds
    s_mov_b32 m0, 52224
    s_nop 0
    buffer_load_dwordx4 v11, s[36:39], s65 offen  lds
    s_mov_b32 m0, 53248
    s_nop 0
    buffer_load_dwordx4 v12, s[36:39], s65 offen  lds
    s_mov_b32 m0, 54272
    s_nop 0
    buffer_load_dwordx4 v13, s[36:39], s65 offen  lds
    s_mov_b32 m0, 55296
    s_nop 0
    buffer_load_dwordx4 v14, s[36:39], s65 offen  lds
    s_mov_b32 m0, 56320
    s_nop 0
    buffer_load_dwordx4 v15, s[36:39], s65 offen  lds
    s_waitcnt vmcnt(24)
    s_barrier
    s_mov_b32 m0, 57344
    s_nop 0
    buffer_load_dwordx4 v16, s[36:39], s65 offen  lds
    s_mov_b32 m0, 58368
    s_nop 0
    buffer_load_dwordx4 v17, s[36:39], s65 offen  lds
    s_mov_b32 m0, 59392
    s_nop 0
    buffer_load_dwordx4 v18, s[36:39], s65 offen  lds
    s_mov_b32 m0, 60416
    s_nop 0
    buffer_load_dwordx4 v19, s[36:39], s65 offen  lds
    s_mov_b32 m0, 61440
    s_nop 0
    buffer_load_dwordx4 v20, s[36:39], s65 offen  lds
    s_mov_b32 m0, 62464
    s_nop 0
    buffer_load_dwordx4 v21, s[36:39], s65 offen  lds
    s_mov_b32 m0, 63488
    s_nop 0
    buffer_load_dwordx4 v22, s[36:39], s65 offen  lds
    s_mov_b32 m0, 64512
    s_nop 0
    buffer_load_dwordx4 v23, s[36:39], s65 offen  lds
    s_barrier
    s_add_u32 s65, s65, 128
    s_cmp_eq_u32 s65, s60
    s_cselect_b32 s65, 0, s65
    s_mov_b32 m0, 0
    s_nop 0
    buffer_load_dwordx4 v8, s[36:39], s65 offen  lds
    s_mov_b32 m0, 1024
    s_nop 0
    buffer_load_dwordx4 v9, s[36:39], s65 offen  lds
    s_mov_b32 m0, 2048
    s_nop 0
    buffer_load_dwordx4 v10, s[36:39], s65 offen  lds
    s_mov_b32 m0, 3072
    s_nop 0
    buffer_load_dwordx4 v11, s[36:39], s65 offen  lds
    s_mov_b32 m0, 4096
    s_nop 0
    buffer_load_dwordx4 v12, s[36:39], s65 offen  lds
    s_mov_b32 m0, 5120
    s_nop 0
    buffer_load_dwordx4 v13, s[36:39], s65 offen  lds
    s_mov_b32 m0, 6144
    s_nop 0
    buffer_load_dwordx4 v14, s[36:39], s65 offen  lds
    s_mov_b32 m0, 7168
    s_nop 0
    buffer_load_dwordx4 v15, s[36:39], s65 offen  lds
    s_waitcnt vmcnt(24)
    s_barrier
    s_mov_b32 m0, 8192
    s_nop 0
    buffer_load_dwordx4 v16, s[36:39], s65 offen  lds
    s_mov_b32 m0, 9216
    s_nop 0
    buffer_load_dwordx4 v17, s[36:39], s65 offen  lds
    s_mov_b32 m0, 10240
    s_nop 0
    buffer_load_dwordx4 v18, s[36:39], s65 offen  lds
    s_mov_b32 m0, 11264
    s_nop 0
    buffer_load_dwordx4 v19, s[36:39], s65 offen  lds
    s_mov_b32 m0, 12288
    s_nop 0
    buffer_load_dwordx4 v20, s[36:39], s65 offen  lds
    s_mov_b32 m0, 13312
    s_nop 0
    buffer_load_dwordx4 v21, s[36:39], s65 offen  lds
    s_mov_b32 m0, 14336
    s_nop 0
    buffer_load_dwordx4 v22, s[36:39], s65 offen  lds
    s_mov_b32 m0, 15360
    s_nop 0
    buffer_load_dwordx4 v23, s[36:39], s65 offen  lds
    s_barrier
    s_add_u32 s65, s65, 128
    s_cmp_eq_u32 s65, s60
    s_cselect_b32 s65, 0, s65
    s_mov_b32 m0, 16384
    s_nop 0
    buffer_load_dwordx4 v8, s[36:39], s65 offen  lds
    s_mov_b32 m0, 17408
    s_nop 0
    buffer_load_dwordx4 v9, s[36:39], s65 offen  lds
    s_mov_b32 m0, 18432
    s_nop 0
    buffer_load_dwordx4 v10, s[36:39], s65 offen  lds
    s_mov_b32 m0, 19456
    s_nop 0
    buffer_load_dwordx4 v11, s[36:39], s65 offen  lds
    s_mov_b32 m0, 20480
    s_nop 0
    buffer_load_dwordx4 v12, s[36:39], s65 offen  lds
    s_mov_b32 m0, 21504
    s_nop 0
    buffer_load_dwordx4 v13, s[36:39], s65 offen  lds
    s_mov_b32 m0, 22528
    s_nop 0
    buffer_load_dwordx4 v14, s[36:39], s65 offen  lds
    s_mov_b32 m0, 23552
    s_nop 0
    buffer_load_dwordx4 v15, s[36:39], s65 offen  lds
    s_waitcnt vmcnt(24)
    s_barrier
    s_mov_b32 m0, 24576
    s_nop 0
    buffer_load_dwordx4 v16, s[36:39], s65 offen  lds
    s_mov_b32 m0, 25600
    s_nop 0
    buffer_load_dwordx4 v17, s[36:39], s65 offen  lds
    s_mov_b32 m0, 26624
    s_nop 0
    buffer_load_dwordx4 v18, s[36:39], s65 offen  lds
    s_mov_b32 m0, 27648
    s_nop 0
    buffer_load_dwordx4 v19, s[36:39], s65 offen  lds
    s_mov_b32 m0, 28672
    s_nop 0
    buffer_load_dwordx4 v20, s[36:39], s65 offen  lds
    s_mov_b32 m0, 29696
    s_nop 0
    buffer_load_dwordx4 v21, s[36:39], s65 offen  lds
    s_mov_b32 m0, 30720
    s_nop 0
    buffer_load_dwordx4 v22, s[36:39], s65 offen  lds
    s_mov_b32 m0, 31744
    s_nop 0
    buffer_load_dwordx4 v23, s[36:39], s65 offen  lds
    s_barrier
    s_add_u32 s65, s65, 128
    s_cmp_eq_u32 s65, s60
    s_cselect_b32 s65, 0, s65
    s_mov_b32 m0, 32768
    s_nop 0
    buffer_load_dwordx4 v8, s[36:39], s65 offen  lds
    s_mov_b32 m0, 33792
    s_nop 0
    buffer_load_dwordx4 v9, s[36:39], s65 offen  lds
    s_mov_b32 m0, 34816
    s_nop 0
    buffer_load_dwordx4 v10, s[36:39], s65 offen  lds
    s_mov_b32 m0, 35840
    s_nop 0
    buffer_load_dwordx4 v11, s[36:39], s65 offen  lds
    s_mov_b32 m0, 36864
    s_nop 0
    buffer_load_dwordx4 v12, s[36:39], s65 offen  lds
    s_mov_b32 m0, 37888
    s_nop 0
    buffer_load_dwordx4 v13, s[36:39], s65 offen  lds
    s_mov_b32 m0, 38912
    s_nop 0
    buffer_load_dwordx4 v14, s[36:39], s65 offen  lds
    s_mov_b32 m0, 39936
    s_nop 0
    buffer_load_dwordx4 v15, s[36:39], s65 offen  lds
    s_waitcnt vmcnt(24)
    s_barrier
    s_mov_b32 m0, 40960
    s_nop 0
    buffer_load_dwordx4 v16, s[36:39], s65 offen  lds
    s_mov_b32 m0, 41984
    s_nop 0
    buffer_load_dwordx4 v17, s[36:39], s65 offen  lds
    s_mov_b32 m0, 43008
    s_nop 0
    buffer_load_dwordx4 v18, s[36:39], s65 offen  lds
    s_mov_b32 m0, 44032
    s_nop 0
    buffer_load_dwordx4 v19, s[36:39], s65 offen  lds
    s_mov_b32 m0, 45056
    s_nop 0
    buffer_load_dwordx4 v20, s[36:39], s65 offen  lds
    s_mov_b32 m0, 46080
    s_nop 0
    buffer_load_dwordx4 v21, s[36:39], s65 offen  lds
    s_mov_b32 m0, 47104
    s_nop 0
    buffer_load_dwordx4 v22, s[36:39], s65 offen  lds
    s_mov_b32 m0, 48128
    s_nop 0
    buffer_load_dwordx4 v23, s[36:39], s65 offen  lds
    s_barrier
    s_add_u32 s65, s65, 128
    s_cmp_eq_u32 s65, s60
    s_cselect_b32 s65, 0, s65
    s_mov_b32 m0, 49152
    s_nop 0
    buffer_load_dwordx4 v8, s[36:39], s65 offen  lds
    s_mov_b32 m0, 50176
    s_nop 0
    buffer_load_dwordx4 v9, s[36:39], s65 offen  lds
    s_mov_b32 m0, 51200
    s_nop 0
    buffer_load_dwordx4 v10, s[36:39], s65 offen  lds
    s_mov_b32 m0, 52224
    s_nop 0
    buffer_load_dwordx4 v11, s[36:39], s65 offen  lds
    s_mov_b32 m0, 53248
    s_nop 0
    buffer_load_dwordx4 v12, s[36:39], s65 offen  lds
    s_mov_b32 m0, 54272
    s_nop 0
    buffer_load_dwordx4 v13, s[36:39], s65 offen  lds
    s_mov_b32 m0, 55296
    s_nop 0
    buffer_load_dwordx4 v14, s[36:39], s65 offen  lds
    s_mov_b32 m0, 56320
    s_nop 0
    buffer_load_dwordx4 v15, s[36:39], s65 offen  lds
    s_waitcnt vmcnt(24)
    s_barrier
    s_mov_b32 m0, 57344
    s_nop 0
    buffer_load_dwordx4 v16, s[36:39], s65 offen  lds
    s_mov_b32 m0, 58368
    s_nop 0
    buffer_load_dwordx4 v17, s[36:39], s65 offen  lds
    s_mov_b32 m0, 59392
    s_nop 0
    buffer_load_dwordx4 v18, s[36:39], s65 offen  lds
    s_mov_b32 m0, 60416
    s_nop 0
    buffer_load_dwordx4 v19, s[36:39], s65 offen  lds
    s_mov_b32 m0, 61440
    s_nop 0
    buffer_load_dwordx4 v20, s[36:39], s65 offen  lds
    s_mov_b32 m0, 62464
    s_nop 0
    buffer_load_dwordx4 v21, s[36:39], s65 offen  lds
    s_mov_b32 m0, 63488
    s_nop 0
    buffer_load_dwordx4 v22, s[36:39], s65 offen  lds
    s_mov_b32 m0, 64512
    s_nop 0
    buffer_load_dwordx4 v23, s[36:39], s65 offen  lds
    s_barrier
    s_add_u32 s65, s65, 128
    s_cmp_eq_u32 s65, s60
    s_cselect_b32 s65, 0, s65
    s_mov_b32 m0, 0
    s_nop 0
    buffer_load_dwordx4 v8, s[36:39], s65 offen  lds
    s_mov_b32 m0, 1024
    s_nop 0
    buffer_load_dwordx4 v9, s[36:39], s65 offen  lds
    s_mov_b32 m0, 2048
    s_nop 0
    buffer_load_dwordx4 v10, s[36:39], s65 offen  lds
    s_mov_b32 m0, 3072
    s_nop 0
    buffer_load_dwordx4 v11, s[36:39], s65 offen  lds
    s_mov_b32 m0, 4096
    s_nop 0
    buffer_load_dwordx4 v12, s[36:39], s65 offen  lds
    s_mov_b32 m0, 5120
    s_nop 0
    buffer_load_dwordx4 v13, s[36:39], s65 offen  lds
    s_mov_b32 m0, 6144
    s_nop 0
    buffer_load_dwordx4 v14, s[36:39], s65 offen  lds
    s_mov_b32 m0, 7168
    s_nop 0
    buffer_load_dwordx4 v15, s[36:39], s65 offen  lds
    s_waitcnt vmcnt(24)
    s_barrier
    s_mov_b32 m0, 8192
    s_nop 0
    buffer_load_dwordx4 v16, s[36:39], s65 offen  lds
    s_mov_b32 m0, 9216
    s_nop 0
    buffer_load_dwordx4 v17, s[36:39], s65 offen  lds
    s_mov_b32 m0, 10240
    s_nop 0
    buffer_load_dwordx4 v18, s[36:39], s65 offen  lds
    s_mov_b32 m0, 11264
    s_nop 0
    buffer_load_dwordx4 v19, s[36:39], s65 offen  lds
    s_mov_b32 m0, 12288
    s_nop 0
    buffer_load_dwordx4 v20, s[36:39], s65 offen  lds
    s_mov_b32 m0, 13312
    s_nop 0
    buffer_load_dwordx4 v21, s[36:39], s65 offen  lds
    s_mov_b32 m0, 14336
    s_nop 0
    buffer_load_dwordx4 v22, s[36:39], s65 offen  lds
    s_mov_b32 m0, 15360
    s_nop 0
    buffer_load_dwordx4 v23, s[36:39], s65 offen  lds
    s_barrier
    s_add_u32 s65, s65, 128
    s_cmp_eq_u32 s65, s60
    s_cselect_b32 s65, 0, s65
    s_mov_b32 m0, 16384
    s_nop 0
    buffer_load_dwordx4 v8, s[36:39], s65 offen  lds
    s_mov_b32 m0, 17408
    s_nop 0
    buffer_load_dwordx4 v9, s[36:39], s65 offen  lds
    s_mov_b32 m0, 18432
    s_nop 0
    buffer_load_dwordx4 v10, s[36:39], s65 offen  lds
    s_mov_b32 m0, 19456
    s_nop 0
    buffer_load_dwordx4 v11, s[36:39], s65 offen  lds
    s_mov_b32 m0, 20480
    s_nop 0
    buffer_load_dwordx4 v12, s[36:39], s65 offen  lds
    s_mov_b32 m0, 21504
    s_nop 0
    buffer_load_dwordx4 v13, s[36:39], s65 offen  lds
    s_mov_b32 m0, 22528
    s_nop 0
    buffer_load_dwordx4 v14, s[36:39], s65 offen  lds
    s_mov_b32 m0, 23552
    s_nop 0
    buffer_load_dwordx4 v15, s[36:39], s65 offen  lds
    s_waitcnt vmcnt(24)
    s_barrier
    s_mov_b32 m0, 24576
    s_nop 0
    buffer_load_dwordx4 v16, s[36:39], s65 offen  lds
    s_mov_b32 m0, 25600
    s_nop 0
    buffer_load_dwordx4 v17, s[36:39], s65 offen  lds
    s_mov_b32 m0, 26624
    s_nop 0
    buffer_load_dwordx4 v18, s[36:39], s65 offen  lds
    s_mov_b32 m0, 27648
    s_nop 0
    buffer_load_dwordx4 v19, s[36:39], s65 offen  lds
    s_mov_b32 m0, 28672
    s_nop 0
    buffer_load_dwordx4 v20, s[36:39], s65 offen  lds
    s_mov_b32 m0, 29696
    s_nop 0
    buffer_load_dwordx4 v21, s[36:39], s65 offen  lds
    s_mov_b32 m0, 30720
    s_nop 0
    buffer_load_dwordx4 v22, s[36:39], s65 offen  lds
    s_mov_b32 m0, 31744
    s_nop 0
    buffer_load_dwordx4 v23, s[36:39], s65 offen  lds
    s_barrier
    s_waitcnt vmcnt(16)
    s_barrier
    s_barrier
    s_waitcnt vmcnt(0)
    s_mov_b32 s56, 13713408
    buffer_load_dword v2, v232, s[44:47], s56 offen sc1
    s_barrier
    s_barrier
    s_waitcnt vmcnt(0)
    s_mov_b32 s57, 0x40000
    s_lshl_b32 s58, s64, 1
L_wpl_15:
    v_cmp_gt_u32 s[88:89], s58, v1
    v_cmp_ne_u32 vcc, 1, v2
    s_nop 3
    s_and_b64 vcc, vcc, s[88:89]
    s_cbranch_vccz L_wpk_16
    s_mov_b32 s56, 13713408
    buffer_load_dword v2, v232, s[44:47], s56 offen sc1
    s_waitcnt vmcnt(0)
    s_sub_u32 s57, s57, 1
    s_cmp_lg_u32 s57, 0
    s_cbranch_scc1 L_wpl_15
L_wpk_16:
    v_lshlrev_b32 v4, 4, v1
    s_add_u32 s65, s82, 0
    s_sub_u32 s67, s65, s64
    s_cmp_ge_u32 s65, s64
    s_cselect_b32 s65, s67, s65
    s_mul_i32 s67, s65, 5120
    s_add_u32 s67, s67, s81
    s_add_u32 s68, s67, 4096
    buffer_load_dwordx4 v[136:139], v4, s[44:47], s67 offen offset:0 sc1
    buffer_load_dwordx4 v[140:143], v4, s[44:47], s67 offen offset:1024 sc1
    buffer_load_dwordx4 v[144:147], v4, s[44:47], s67 offen offset:2048 sc1
    buffer_load_dwordx4 v[148:151], v4, s[44:47], s67 offen offset:3072 sc1
    buffer_load_dwordx4 v[152:155], v4, s[44:47], s68 offen sc1
    s_add_u32 s65, s82, 1
    s_sub_u32 s67, s65, s64
    s_cmp_ge_u32 s65, s64
    s_cselect_b32 s65, s67, s65
    s_mul_i32 s67, s65, 5120
    s_add_u32 s67, s67, s81
    s_add_u32 s68, s67, 4096
    buffer_load_dwordx4 v[156:159], v4, s[44:47], s67 offen offset:0 sc1
    buffer_load_dwordx4 v[160:163], v4, s[44:47], s67 offen offset:1024 sc1
    buffer_load_dwordx4 v[164:167], v4, s[44:47], s67 offen offset:2048 sc1
    buffer_load_dwordx4 v[168:171], v4, s[44:47], s67 offen offset:3072 sc1
    buffer_load_dwordx4 v[172:175], v4, s[44:47], s68 offen sc1
    s_add_u32 s65, s82, 2
    s_sub_u32 s67, s65, s64
    s_cmp_ge_u32 s65, s64
    s_cselect_b32 s65, s67, s65
    s_mul_i32 s67, s65, 5120
    s_add_u32 s67, s67, s81
    s_add_u32 s68, s67, 4096
    buffer_load_dwordx4 v[176:179], v4, s[44:47], s67 offen offset:0 sc1
    buffer_load_dwordx4 v[180:183], v4, s[44:47], s67 offen offset:1024 sc1
    buffer_load_dwordx4 v[184:187], v4, s[44:47], s67 offen offset:2048 sc1
    buffer_load_dwordx4 v[188:191], v4, s[44:47], s67 offen offset:3072 sc1
    buffer_load_dwordx4 v[192:195], v4, s[44:47], s68 offen sc1
    s_add_u32 s65, s82, 3
    s_sub_u32 s67, s65, s64
    s_cmp_ge_u32 s65, s64
    s_cselect_b32 s65, s67, s65
    s_mul_i32 s67, s65, 5120
    s_add_u32 s67, s67, s81
    s_add_u32 s68, s67, 4096
    buffer_load_dwordx4 v[196:199], v4, s[44:47], s67 offen offset:0 sc1
    buffer_load_dwordx4 v[200:203], v4, s[44:47], s67 offen offset:1024 sc1
    buffer_load_dwordx4 v[204:207], v4, s[44:47], s67 offen offset:2048 sc1
    buffer_load_dwordx4 v[208:211], v4, s[44:47], s67 offen offset:3072 sc1
    buffer_load_dwordx4 v[212:215], v4, s[44:47], s68 offen sc1
    s_cmp_eq_u32 s33, 1
    s_cbranch_scc1 L_attn
    s_branch L_bar3
L_ldw0:
    s_and_b32 s100, s2, 1
    s_bfe_u32 s101, s2, 0x20001
    s_lshr_b32 s85, s2, 3
    s_cmp_lt_u32 s85, 18
    s_cselect_b32 s33, 1, 0
    s_cbranch_scc0 L_role_bw0
    s_mul_i32 s34, s100, 9
    s_lshr_b32 s58, s85, 1
    s_add_u32 s34, s34, s58
    s_lshl_b32 s35, s101, 1
    s_and_b32 s58, s85, 1
    s_add_u32 s35, s35, s58
    s_branch L_role_donew0
L_role_bw0:
    s_mul_i32 s58, s101, 14
    s_add_u32 s58, s58, s85
    s_sub_u32 s58, s58, 18
    s_lshr_b32 s35, s58, 3
    s_and_b32 s58, s58, 7
    s_lshl_b32 s34, s100, 3
    s_add_u32 s34, s34, s58
L_role_donew0:
    s_mul_i32 s58, s100, 9
    s_lshl_b32 s59, s100, 3
    s_cmp_eq_u32 s33, 1
    s_cselect_b32 s58, s58, s59
    s_sub_u32 s3, s34, s58
    s_and_b32 s58, s35, 1
    s_mul_i32 s58, s58, 5
    s_add_u32 s3, s3, s58
    s_cmp_eq_u32 s33, 1
    s_cselect_b32 s58, 0, 2
    s_add_u32 s3, s3, s58
    s_mul_i32 s58, s3, 205
    s_lshr_b32 s58, s58, 11
    s_mul_i32 s58, s58, 10
    s_sub_u32 s3, s3, s58
    s_and_b32 s56, s2, 7
    s_lshr_b32 s57, s2, 3
    s_lshl_b32 s78, s56, 2
    s_lshr_b32 s58, s57, 3
    s_add_u32 s78, s78, s58
    s_and_b32 s79, s57, 7
    s_and_b32 s83, s35, 1
    s_mul_i32 s76, s34, 114
    s_sub_u32 s76, s76, 14
    s_cmp_eq_u32 s33, 1
    s_mov_b32 s77, 3456
    s_cselect_b32 s77, 3840, s77
    s_lshl_b32 s58, s34, 3
    s_add_u32 s58, s58, s35
    s_mul_i32 s59, s34, 7
    s_add_u32 s59, s59, s35
    s_add_u32 s59, s59, 144
    s_cmp_eq_u32 s33, 1
    s_cselect_b32 s84, s58, s59
    v_lshrrev_b32 v2, 2, v1
    v_mul_lo_u32 v2, v2, s77
    v_and_b32 v3, 1, v1
    v_lshl_add_u32 v2, v3, 4, v2
    v_lshrrev_b32 v3, 1, v1
    v_lshrrev_b32 v4, 5, v1
    v_xor_b32 v3, v3, v4
    v_and_b32 v3, 1, v3
    v_cmp_eq_u32 vcc, 1, v3
    s_mul_i32 s60, s35, 160
    s_lshl_b32 s61, s83, 5
    s_add_u32 s61, s61, s60
    s_lshl_b32 s62, s35, 9
    s_lshl_b32 s63, s77, 5
    s_mul_i32 s66, s63, s3
    s_lshl_b32 s66, s66, 1
    s_lshl_b32 s68, s77, 4
    s_add_u32 s67, s66, s68
    s_mul_i32 s69, s63, 20
    s_add_u32 s56, s62, 0
    s_add_u32 s57, s56, 32
    s_add_u32 s58, s61, 0
    s_add_u32 s59, s58, 32
    s_cmp_eq_u32 s33, 1
    s_cselect_b32 s56, s58, s56
    s_cselect_b32 s57, s59, s57
    v_mov_b32 v4, s56
    v_mov_b32 v5, s57
    v_cndmask_b32 v4, v4, v5, vcc
    v_add_u32 v8, v4, v2
    s_add_u32 s56, s62, 64
    s_add_u32 s57, s56, 32
    s_add_u32 s58, s61, 64
    s_add_u32 s59, s58, 32
    s_cmp_eq_u32 s33, 1
    s_cselect_b32 s56, s58, s56
    s_cselect_b32 s57, s59, s57
    v_mov_b32 v4, s56
    v_mov_b32 v5, s57
    v_cndmask_b32 v4, v4, v5, vcc
    v_add_u32 v9, v4, v2
    s_add_u32 s56, s62, 128
    s_add_u32 s57, s56, 32
    s_add_u32 s58, s61, 1280
    s_add_u32 s59, s58, 32
    s_cmp_eq_u32 s33, 1
    s_cselect_b32 s56, s58, s56
    s_cselect_b32 s57, s59, s57
    v_mov_b32 v4, s56
    v_mov_b32 v5, s57
    v_cndmask_b32 v4, v4, v5, vcc
    v_add_u32 v10, v4, v2
    s_add_u32 s56, s62, 192
    s_add_u32 s57, s56, 32
    s_add_u32 s58, s61, 1344
    s_add_u32 s59, s58, 32
    s_cmp_eq_u32 s33, 1
    s_cselect_b32 s56, s58, s56
    s_cselect_b32 s57, s59, s57
    v_mov_b32 v4, s56
    v_mov_b32 v5, s57
    v_cndmask_b32 v4, v4, v5, vcc
    v_add_u32 v11, v4, v2
    s_waitcnt lgkmcnt(0)
    s_mov_b32 s36, s8
    s_and_b32 s37, s9, 0xffff
    s_mov_b32 s38, 2621440
    s_mov_b32 s39, 0x20000
    s_cmp_eq_u32 s33, 1
    s_cselect_b32 s40, s10, s16
    s_cselect_b32 s56, s11, s17
    s_mov_b32 s42, 2211840
    s_cselect_b32 s42, 2457600, s42
    s_and_b32 s41, s56, 0xffff
    s_mov_b32 s43, 0x20000
    s_mov_b32 s44, s30
    s_and_b32 s45, s31, 0xffff
    s_mov_b32 s46, 14680064
    s_mov_b32 s47, 0x20000
    s_mov_b32 s96, s28
    s_and_b32 s97, s29, 0xffff
    s_mov_b32 s98, 256
    s_mov_b32 s99, 0x20000
    s_mov_b32 m0, 65536
    s_nop 0
    buffer_load_dwordx4 v8, s[40:43], s66 offen  lds
    s_mov_b32 m0, 67584
    s_nop 0
    buffer_load_dwordx4 v9, s[40:43], s66 offen  lds
    s_mov_b32 m0, 69632
    s_nop 0
    buffer_load_dwordx4 v10, s[40:43], s66 offen  lds
    s_mov_b32 m0, 71680
    s_nop 0
    buffer_load_dwordx4 v11, s[40:43], s66 offen  lds
    s_mov_b32 m0, 66560
    s_nop 0
    buffer_load_dwordx4 v8, s[40:43], s67 offen  lds
    s_mov_b32 m0, 68608
    s_nop 0
    buffer_load_dwordx4 v9, s[40:43], s67 offen  lds
    s_mov_b32 m0, 70656
    s_nop 0
    buffer_load_dwordx4 v10, s[40:43], s67 offen  lds
    s_mov_b32 m0, 72704
    s_nop 0
    buffer_load_dwordx4 v11, s[40:43], s67 offen  lds
    s_add_u32 s66, s66, s63
    s_cmp_eq_u32 s66, s69
    s_cselect_b32 s66, 0, s66
    s_add_u32 s67, s66, s68
    s_mov_b32 m0, 81920
    s_nop 0
    buffer_load_dwordx4 v8, s[40:43], s66 offen  lds
    s_mov_b32 m0, 83968
    s_nop 0
    buffer_load_dwordx4 v9, s[40:43], s66 offen  lds
    s_mov_b32 m0, 86016
    s_nop 0
    buffer_load_dwordx4 v10, s[40:43], s66 offen  lds
    s_mov_b32 m0, 88064
    s_nop 0
    buffer_load_dwordx4 v11, s[40:43], s66 offen  lds
    s_mov_b32 m0, 82944
    s_nop 0
    buffer_load_dwordx4 v8, s[40:43], s67 offen  lds
    s_mov_b32 m0, 84992
    s_nop 0
    buffer_load_dwordx4 v9, s[40:43], s67 offen  lds
    s_mov_b32 m0, 87040
    s_nop 0
    buffer_load_dwordx4 v10, s[40:43], s67 offen  lds
    s_mov_b32 m0, 89088
    s_nop 0
    buffer_load_dwordx4 v11, s[40:43], s67 offen  lds
    s_add_u32 s66, s66, s63
    s_cmp_eq_u32 s66, s69
    s_cselect_b32 s66, 0, s66
    s_add_u32 s67, s66, s68
    s_cmp_lt_u32 s32, 2
    s_cbranch_scc1 L_p3o_18
    s_add_u32 s56, s32, 2
    s_sub_u32 s57, s32, 4
    s_cmp_ge_u32 s32, 4
    s_cselect_b32 s56, s57, s56
    s_mul_i32 s58, s56, 9
    s_mul_i32 s80, s78, 54
    s_add_u32 s80, s80, s58
    s_lshl_b32 s80, s80, 12
    s_add_u32 s59, s58, 20
    s_mov_b32 s64, 9
    s_mov_b32 s62, 2147483648
    s_branch L_p3d_19
L_p3o_18:
    s_mul_i32 s59, s32, 10
    s_mul_i32 s80, s78, 20
    s_add_u32 s80, s80, s59
    s_lshl_b32 s80, s80, 12
    s_add_u32 s80, s80, 7340032
    s_mov_b32 s64, 10
    s_mov_b32 s62, 0
L_p3d_19:
    s_mul_i32 s81, s79, 74
    s_add_u32 s81, s81, s59
    s_mul_i32 s81, s81, 5120
    s_add_u32 s81, s81, 10485760
    s_mov_b32 s82, s79
    s_sub_u32 s60, s82, s64
    s_cmp_ge_u32 s82, s64
    s_cselect_b32 s82, s60, s82
    v_lshrrev_b32 v6, 1, v1
    v_add_u32 v6, s59, v6
    v_mul_u32_u24 v6, 10, v6
    s_mul_i32 s60, s79, 5
    s_lshr_b32 s60, s60, 2
    v_and_b32 v7, 1, v1
    v_add_u32 v6, v6, v7
    v_add_u32 v6, s60, v6
    v_mul_u32_u24 v7, 16384, v6
    v_lshrrev_b32 v7, 16, v7
    v_cmp_gt_u32 vcc, 448, v6
    v_subrev_u32 v6, 448, v6
    v_and_b32 v6, 0x3ff, v6
    v_mul_u32_u24 v6, 21846, v6
    v_lshrrev_b32 v6, 16, v6
    v_add_u32 v6, 112, v6
    v_cndmask_b32 v6, v6, v7, vcc
    v_lshlrev_b32 v6, 6, v6
    s_lshl_b32 s60, s64, 1
    v_cmp_gt_u32 vcc, s60, v1
    v_mov_b32 v7, 2147483648
    s_nop 0
    v_cndmask_b32 v232, v7, v6, vcc
    s_cmp_eq_u32 s33, 1
    s_cbranch_scc0 L_aa_20
    s_and_b32 s56, s32, 3
    s_lshr_b32 s57, s32, 2
    s_mul_i32 s58, s57, 31232
    s_mul_i32 s59, s56, 40
    s_add_u32 s58, s58, s59
    s_add_u32 s58, s58, 28864
    v_mul_u32_u24 v240, 488, v1
    v_add_u32 v240, s58, v240
    v_and_b32 v60, 48, v1
    v_and_b32 v61, 3, v1
    v_lshl_add_u32 v60, v61, 2, v60
    v_bfe_u32 v61, v1, 2, 2
    v_add_u32 v60, v60, v61
    v_mul_u32_u24 v241, 488, v60
    v_add_u32 v241, s58, v241
    s_mul_i32 s58, s57, 11264
    s_add_u32 s58, s58, s59
    s_add_u32 s58, s58, 133120
    v_mul_u32_u24 v242, 176, v1
    v_add_u32 v242, s58, v242
    s_add_u32 s56, s32, 0
    s_lshr_b32 s57, s56, 1
    s_and_b32 s56, s56, 1
    s_lshl_b32 s58, s56, 6
    v_add_u32 v60, s58, v1
    v_add_u32 v61, 14, v60
    v_and_b32 v62, 1, v61
    v_lshrrev_b32 v63, 1, v61
    v_lshl_add_u32 v62, v62, 6, v63
    v_min_u32 v62, 127, v62
    v_mul_u32_u24 v62, 176, v62
    s_lshl_b32 s59, s57, 4
    s_add_u32 s59, s59, 133120
    v_add_u32 v243, s59, v62
    s_add_u32 s59, s76, 14
    v_add_u32 v63, s59, v60
    s_mul_i32 s60, s35, 10
    s_add_u32 s60, s60, s57
    s_lshr_b32 s61, s60, 2
    s_and_b32 s60, s60, 3
    s_lshl_b32 s61, s61, 12
    s_lshl_b32 s60, s60, 8
    s_add_u32 s61, s61, s60
    s_add_u32 s71, s61, 7340032
    v_lshrrev_b32 v64, 6, v63
    v_mul_u32_u24 v64, 81920, v64
    v_bfe_u32 v65, v63, 4, 2
    v_lshl_add_u32 v64, v65, 10, v64
    v_and_b32 v65, 15, v63
    v_lshl_add_u32 v64, v65, 4, v64
    v_cmp_gt_u32 vcc, 114, v60
    s_nop 3
    s_mov_b64 s[88:89], vcc
    v_cmp_gt_u32 vcc, 2048, v63
    s_nop 3
    s_and_b64 vcc, vcc, s[88:89]
    v_mov_b32 v65, 2147483648
    s_nop 1
    v_cndmask_b32 v244, v65, v64, vcc
    s_add_u32 s56, s32, 8
    s_lshr_b32 s57, s56, 1
    s_and_b32 s56, s56, 1
    s_lshl_b32 s58, s56, 6
    v_add_u32 v60, s58, v1
    v_add_u32 v61, 14, v60
    v_and_b32 v62, 1, v61
    v_lshrrev_b32 v63, 1, v61
    v_lshl_add_u32 v62, v62, 6, v63
    v_min_u32 v62, 127, v62
    v_mul_u32_u24 v62, 176, v62
    s_lshl_b32 s59, s57, 4
    s_add_u32 s59, s59, 133120
    v_add_u32 v245, s59, v62
    s_add_u32 s59, s76, 14
    v_add_u32 v63, s59, v60
    s_mul_i32 s60, s35, 10
    s_add_u32 s60, s60, s57
    s_lshr_b32 s61, s60, 2
    s_and_b32 s60, s60, 3
    s_lshl_b32 s61, s61, 12
    s_lshl_b32 s60, s60, 8
    s_add_u32 s61, s61, s60
    s_add_u32 s72, s61, 7340032
    v_lshrrev_b32 v64, 6, v63
    v_mul_u32_u24 v64, 81920, v64
    v_bfe_u32 v65, v63, 4, 2
    v_lshl_add_u32 v64, v65, 10, v64
    v_and_b32 v65, 15, v63
    v_lshl_add_u32 v64, v65, 4, v64
    v_cmp_gt_u32 vcc, 114, v60
    s_nop 3
    s_mov_b64 s[88:89], vcc
    v_cmp_gt_u32 vcc, 2048, v63
    s_nop 3
    s_and_b64 vcc, vcc, s[88:89]
    v_mov_b32 v65, 2147483648
    s_nop 1
    v_cndmask_b32 v246, v65, v64, vcc
    s_add_u32 s56, s32, 16
    s_lshr_b32 s57, s56, 1
    s_and_b32 s56, s56, 1
    s_lshl_b32 s58, s56, 6
    v_add_u32 v60, s58, v1
    v_add_u32 v61, 14, v60
    v_and_b32 v62, 1, v61
    v_lshrrev_b32 v63, 1, v61
    v_lshl_add_u32 v62, v62, 6, v63
    v_min_u32 v62, 127, v62
    v_mul_u32_u24 v62, 176, v62
    s_lshl_b32 s59, s57, 4
    s_add_u32 s59, s59, 133120
    v_add_u32 v247, s59, v62
    s_add_u32 s59, s76, 14
    v_add_u32 v63, s59, v60
    s_mul_i32 s60, s35, 10
    s_add_u32 s60, s60, s57
    s_lshr_b32 s61, s60, 2
    s_and_b32 s60, s60, 3
    s_lshl_b32 s61, s61, 12
    s_lshl_b32 s60, s60, 8
    s_add_u32 s61, s61, s60
    s_add_u32 s73, s61, 7340032
    v_lshrrev_b32 v64, 6, v63
    v_mul_u32_u24 v64, 81920, v64
    v_bfe_u32 v65, v63, 4, 2
    v_lshl_add_u32 v64, v65, 10, v64
    v_and_b32 v65, 15, v63
    v_lshl_add_u32 v64, v65, 4, v64
    v_cmp_gt_u32 vcc, 114, v60
    s_nop 3
    s_mov_b64 s[88:89], vcc
    v_cmp_gt_u32 vcc, 2048, v63
    s_nop 3
    s_and_b64 vcc, vcc, s[88:89]
    v_mov_b32 v65, 2147483648
    s_nop 1
    v_cndmask_b32 v248, v65, v64, vcc
L_aa_20:
    s_waitcnt vmcnt(8)
    s_barrier
    s_mov_b32 m0, 98304
    s_nop 0
    buffer_load_dwordx4 v8, s[40:43], s66 offen  lds
    s_mov_b32 m0, 100352
    s_nop 0
    buffer_load_dwordx4 v9, s[40:43], s66 offen  lds
    s_mov_b32 m0, 102400
    s_nop 0
    buffer_load_dwordx4 v10, s[40:43], s66 offen  lds
    s_mov_b32 m0, 104448
    s_nop 0
    buffer_load_dwordx4 v11, s[40:43], s66 offen  lds
    s_mov_b32 m0, 99328
    s_nop 0
    buffer_load_dwordx4 v8, s[40:43], s67 offen  lds
    s_mov_b32 m0, 101376
    s_nop 0
    buffer_load_dwordx4 v9, s[40:43], s67 offen  lds
    s_mov_b32 m0, 103424
    s_nop 0
    buffer_load_dwordx4 v10, s[40:43], s67 offen  lds
    s_mov_b32 m0, 105472
    s_nop 0
    buffer_load_dwordx4 v11, s[40:43], s67 offen  lds
    s_add_u32 s66, s66, s63
    s_cmp_eq_u32 s66, s69
    s_cselect_b32 s66, 0, s66
    s_add_u32 s67, s66, s68
    s_mov_b32 m0, 114688
    s_nop 0
    buffer_load_dwordx4 v8, s[40:43], s66 offen  lds
    s_mov_b32 m0, 116736
    s_nop 0
    buffer_load_dwordx4 v9, s[40:43], s66 offen  lds
    s_mov_b32 m0, 118784
    s_nop 0
    buffer_load_dwordx4 v10, s[40:43], s66 offen  lds
    s_mov_b32 m0, 120832
    s_nop 0
    buffer_load_dwordx4 v11, s[40:43], s66 offen  lds
    s_mov_b32 m0, 115712
    s_nop 0
    buffer_load_dwordx4 v8, s[40:43], s67 offen  lds
    s_mov_b32 m0, 117760
    s_nop 0
    buffer_load_dwordx4 v9, s[40:43], s67 offen  lds
    s_mov_b32 m0, 119808
    s_nop 0
    buffer_load_dwordx4 v10, s[40:43], s67 offen  lds
    s_mov_b32 m0, 121856
    s_nop 0
    buffer_load_dwordx4 v11, s[40:43], s67 offen  lds
    s_add_u32 s66, s66, s63
    s_cmp_eq_u32 s66, s69
    s_cselect_b32 s66, 0, s66
    s_add_u32 s67, s66, s68
    s_waitcnt vmcnt(16)
    s_barrier
    s_mov_b32 m0, 65536
    s_nop 0
    buffer_load_dwordx4 v8, s[40:43], s66 offen  lds
    s_mov_b32 m0, 67584
    s_nop 0
    buffer_load_dwordx4 v9, s[40:43], s66 offen  lds
    s_mov_b32 m0, 69632
    s_nop 0
    buffer_load_dwordx4 v10, s[40:43], s66 offen  lds
    s_mov_b32 m0, 71680
    s_nop 0
    buffer_load_dwordx4 v11, s[40:43], s66 offen  lds
    s_mov_b32 m0, 66560
    s_nop 0
    buffer_load_dwordx4 v8, s[40:43], s67 offen  lds
    s_mov_b32 m0, 68608
    s_nop 0
    buffer_load_dwordx4 v9, s[40:43], s67 offen  lds
    s_mov_b32 m0, 70656
    s_nop 0
    buffer_load_dwordx4 v10, s[40:43], s67 offen  lds
    s_mov_b32 m0, 72704
    s_nop 0
    buffer_load_dwordx4 v11, s[40:43], s67 offen  lds
    s_add_u32 s66, s66, s63
    s_cmp_eq_u32 s66, s69
    s_cselect_b32 s66, 0, s66
    s_add_u32 s67, s66, s68
    s_waitcnt vmcnt(16)
    s_barrier
    s_mov_b32 m0, 81920
    s_nop 0
    buffer_load_dwordx4 v8, s[40:43], s66 offen  lds
    s_mov_b32 m0, 83968
    s_nop 0
    buffer_load_dwordx4 v9, s[40:43], s66 offen  lds
    s_mov_b32 m0, 86016
    s_nop 0
    buffer_load_dwordx4 v10, s[40:43], s66 offen  lds
    s_mov_b32 m0, 88064
    s_nop 0
    buffer_load_dwordx4 v11, s[40:43], s66 offen  lds
    s_mov_b32 m0, 82944
    s_nop 0
    buffer_load_dwordx4 v8, s[40:43], s67 offen  lds
    s_mov_b32 m0, 84992
    s_nop 0
    buffer_load_dwordx4 v9, s[40:43], s67 offen  lds
    s_mov_b32 m0, 87040
    s_nop 0
    buffer_load_dwordx4 v10, s[40:43], s67 offen  lds
    s_mov_b32 m0, 89088
    s_nop 0
    buffer_load_dwordx4 v11, s[40:43], s67 offen  lds
    s_add_u32 s66, s66, s63
    s_cmp_eq_u32 s66, s69
    s_cselect_b32 s66, 0, s66
    s_add_u32 s67, s66, s68
    s_waitcnt vmcnt(16)
    s_barrier
    s_mov_b32 m0, 98304
    s_nop 0
    buffer_load_dwordx4 v8, s[40:43], s66 offen  lds
    s_mov_b32 m0, 100352
    s_nop 0
    buffer_load_dwordx4 v9, s[40:43], s66 offen  lds
    s_mov_b32 m0, 102400
    s_nop 0
    buffer_load_dwordx4 v10, s[40:43], s66 offen  lds
    s_mov_b32 m0, 104448
    s_nop 0
    buffer_load_dwordx4 v11, s[40:43], s66 offen  lds
    s_mov_b32 m0, 99328
    s_nop 0
    buffer_load_dwordx4 v8, s[40:43], s67 offen  lds
    s_mov_b32 m0, 101376
    s_nop 0
    buffer_load_dwordx4 v9, s[40:43], s67 offen  lds
    s_mov_b32 m0, 103424
    s_nop 0
    buffer_load_dwordx4 v10, s[40:43], s67 offen  lds
    s_mov_b32 m0, 105472
    s_nop 0
    buffer_load_dwordx4 v11, s[40:43], s67 offen  lds
    s_add_u32 s66, s66, s63
    s_cmp_eq_u32 s66, s69
    s_cselect_b32 s66, 0, s66
    s_add_u32 s67, s66, s68
    s_waitcnt vmcnt(16)
    s_barrier
    s_mov_b32 m0, 114688
    s_nop 0
    buffer_load_dwordx4 v8, s[40:43], s66 offen  lds
    s_mov_b32 m0, 116736
    s_nop 0
    buffer_load_dwordx4 v9, s[40:43], s66 offen  lds
    s_mov_b32 m0, 118784
    s_nop 0
    buffer_load_dwordx4 v10, s[40:43], s66 offen  lds
    s_mov_b32 m0, 120832
    s_nop 0
    buffer_load_dwordx4 v11, s[40:43], s66 offen  lds
    s_mov_b32 m0, 115712
    s_nop 0
    buffer_load_dwordx4 v8, s[40:43], s67 offen  lds
    s_mov_b32 m0, 117760
    s_nop 0
    buffer_load_dwordx4 v9, s[40:43], s67 offen  lds
    s_mov_b32 m0, 119808
    s_nop 0
    buffer_load_dwordx4 v10, s[40:43], s67 offen  lds
    s_mov_b32 m0, 121856
    s_nop 0
    buffer_load_dwordx4 v11, s[40:43], s67 offen  lds
    s_add_u32 s66, s66, s63
    s_cmp_eq_u32 s66, s69
    s_cselect_b32 s66, 0, s66
    s_add_u32 s67, s66, s68
    s_waitcnt vmcnt(16)
    s_barrier
    s_mov_b32 m0, 65536
    s_nop 0
    buffer_load_dwordx4 v8, s[40:43], s66 offen  lds
    s_mov_b32 m0, 67584
    s_nop 0
    buffer_load_dwordx4 v9, s[40:43], s66 offen  lds
    s_mov_b32 m0, 69632
    s_nop 0
    buffer_load_dwordx4 v10, s[40:43], s66 offen  lds
    s_mov_b32 m0, 71680
    s_nop 0
    buffer_load_dwordx4 v11, s[40:43], s66 offen  lds
    s_mov_b32 m0, 66560
    s_nop 0
    buffer_load_dwordx4 v8, s[40:43], s67 offen  lds
    s_mov_b32 m0, 68608
    s_nop 0
    buffer_load_dwordx4 v9, s[40:43], s67 offen  lds
    s_mov_b32 m0, 70656
    s_nop 0
    buffer_load_dwordx4 v10, s[40:43], s67 offen  lds
    s_mov_b32 m0, 72704
    s_nop 0
    buffer_load_dwordx4 v11, s[40:43], s67 offen  lds
    s_add_u32 s66, s66, s63
    s_cmp_eq_u32 s66, s69
    s_cselect_b32 s66, 0, s66
    s_add_u32 s67, s66, s68
    s_waitcnt vmcnt(16)
    s_barrier
    s_mov_b32 m0, 81920
    s_nop 0
    buffer_load_dwordx4 v8, s[40:43], s66 offen  lds
    s_mov_b32 m0, 83968
    s_nop 0
    buffer_load_dwordx4 v9, s[40:43], s66 offen  lds
    s_mov_b32 m0, 86016
    s_nop 0
    buffer_load_dwordx4 v10, s[40:43], s66 offen  lds
    s_mov_b32 m0, 88064
    s_nop 0
    buffer_load_dwordx4 v11, s[40:43], s66 offen  lds
    s_mov_b32 m0, 82944
    s_nop 0
    buffer_load_dwordx4 v8, s[40:43], s67 offen  lds
    s_mov_b32 m0, 84992
    s_nop 0
    buffer_load_dwordx4 v9, s[40:43], s67 offen  lds
    s_mov_b32 m0, 87040
    s_nop 0
    buffer_load_dwordx4 v10, s[40:43], s67 offen  lds
    s_mov_b32 m0, 89088
    s_nop 0
    buffer_load_dwordx4 v11, s[40:43], s67 offen  lds
    s_add_u32 s66, s66, s63
    s_cmp_eq_u32 s66, s69
    s_cselect_b32 s66, 0, s66
    s_add_u32 s67, s66, s68
    s_waitcnt vmcnt(16)
    s_barrier
    s_mov_b32 m0, 98304
    s_nop 0
    buffer_load_dwordx4 v8, s[40:43], s66 offen  lds
    s_mov_b32 m0, 100352
    s_nop 0
    buffer_load_dwordx4 v9, s[40:43], s66 offen  lds
    s_mov_b32 m0, 102400
    s_nop 0
    buffer_load_dwordx4 v10, s[40:43], s66 offen  lds
    s_mov_b32 m0, 104448
    s_nop 0
    buffer_load_dwordx4 v11, s[40:43], s66 offen  lds
    s_mov_b32 m0, 99328
    s_nop 0
    buffer_load_dwordx4 v8, s[40:43], s67 offen  lds
    s_mov_b32 m0, 101376
    s_nop 0
    buffer_load_dwordx4 v9, s[40:43], s67 offen  lds
    s_mov_b32 m0, 103424
    s_nop 0
    buffer_load_dwordx4 v10, s[40:43], s67 offen  lds
    s_mov_b32 m0, 105472
    s_nop 0
    buffer_load_dwordx4 v11, s[40:43], s67 offen  lds
    s_add_u32 s66, s66, s63
    s_cmp_eq_u32 s66, s69
    s_cselect_b32 s66, 0, s66
    s_add_u32 s67, s66, s68
    s_waitcnt vmcnt(16)
    s_barrier
    s_mov_b32 m0, 114688
    s_nop 0
    buffer_load_dwordx4 v8, s[40:43], s66 offen  lds
    s_mov_b32 m0, 116736
    s_nop 0
    buffer_load_dwordx4 v9, s[40:43], s66 offen  lds
    s_mov_b32 m0, 118784
    s_nop 0
    buffer_load_dwordx4 v10, s[40:43], s66 offen  lds
    s_mov_b32 m0, 120832
    s_nop 0
    buffer_load_dwordx4 v11, s[40:43], s66 offen  lds
    s_mov_b32 m0, 115712
    s_nop 0
    buffer_load_dwordx4 v8, s[40:43], s67 offen  lds
    s_mov_b32 m0, 117760
    s_nop 0
    buffer_load_dwordx4 v9, s[40:43], s67 offen  lds
    s_mov_b32 m0, 119808
    s_nop 0
    buffer_load_dwordx4 v10, s[40:43], s67 offen  lds
    s_mov_b32 m0, 121856
    s_nop 0
    buffer_load_dwordx4 v11, s[40:43], s67 offen  lds
    s_add_u32 s66, s66, s63
    s_cmp_eq_u32 s66, s69
    s_cselect_b32 s66, 0, s66
    s_add_u32 s67, s66, s68
    s_waitcnt vmcnt(16)
    s_barrier
    s_mov_b32 m0, 65536
    s_nop 0
    buffer_load_dwordx4 v8, s[40:43], s66 offen  lds
    s_mov_b32 m0, 67584
    s_nop 0
    buffer_load_dwordx4 v9, s[40:43], s66 offen  lds
    s_mov_b32 m0, 69632
    s_nop 0
    buffer_load_dwordx4 v10, s[40:43], s66 offen  lds
    s_mov_b32 m0, 71680
    s_nop 0
    buffer_load_dwordx4 v11, s[40:43], s66 offen  lds
    s_mov_b32 m0, 66560
    s_nop 0
    buffer_load_dwordx4 v8, s[40:43], s67 offen  lds
    s_mov_b32 m0, 68608
    s_nop 0
    buffer_load_dwordx4 v9, s[40:43], s67 offen  lds
    s_mov_b32 m0, 70656
    s_nop 0
    buffer_load_dwordx4 v10, s[40:43], s67 offen  lds
    s_mov_b32 m0, 72704
    s_nop 0
    buffer_load_dwordx4 v11, s[40:43], s67 offen  lds
    s_add_u32 s66, s66, s63
    s_cmp_eq_u32 s66, s69
    s_cselect_b32 s66, 0, s66
    s_add_u32 s67, s66, s68
    s_waitcnt vmcnt(16)
    s_barrier
    s_mov_b32 m0, 81920
    s_nop 0
    buffer_load_dwordx4 v8, s[40:43], s66 offen  lds
    s_mov_b32 m0, 83968
    s_nop 0
    buffer_load_dwordx4 v9, s[40:43], s66 offen  lds
    s_mov_b32 m0, 86016
    s_nop 0
    buffer_load_dwordx4 v10, s[40:43], s66 offen  lds
    s_mov_b32 m0, 88064
    s_nop 0
    buffer_load_dwordx4 v11, s[40:43], s66 offen  lds
    s_mov_b32 m0, 82944
    s_nop 0
    buffer_load_dwordx4 v8, s[40:43], s67 offen  lds
    s_mov_b32 m0, 84992
    s_nop 0
    buffer_load_dwordx4 v9, s[40:43], s67 offen  lds
    s_mov_b32 m0, 87040
    s_nop 0
    buffer_load_dwordx4 v10, s[40:43], s67 offen  lds
    s_mov_b32 m0, 89088
    s_nop 0
    buffer_load_dwordx4 v11, s[40:43], s67 offen  lds
    s_add_u32 s66, s66, s63
    s_cmp_eq_u32 s66, s69
    s_cselect_b32 s66, 0, s66
    s_add_u32 s67, s66, s68
    s_waitcnt vmcnt(16)
    s_barrier
    s_mov_b32 m0, 98304
    s_nop 0
    buffer_load_dwordx4 v8, s[40:43], s66 offen  lds
    s_mov_b32 m0, 100352
    s_nop 0
    buffer_load_dwordx4 v9, s[40:43], s66 offen  lds
    s_mov_b32 m0, 102400
    s_nop 0
    buffer_load_dwordx4 v10, s[40:43], s66 offen  lds
    s_mov_b32 m0, 104448
    s_nop 0
    buffer_load_dwordx4 v11, s[40:43], s66 offen  lds
    s_mov_b32 m0, 99328
    s_nop 0
    buffer_load_dwordx4 v8, s[40:43], s67 offen  lds
    s_mov_b32 m0, 101376
    s_nop 0
    buffer_load_dwordx4 v9, s[40:43], s67 offen  lds
    s_mov_b32 m0, 103424
    s_nop 0
    buffer_load_dwordx4 v10, s[40:43], s67 offen  lds
    s_mov_b32 m0, 105472
    s_nop 0
    buffer_load_dwordx4 v11, s[40:43], s67 offen  lds
    s_add_u32 s66, s66, s63
    s_cmp_eq_u32 s66, s69
    s_cselect_b32 s66, 0, s66
    s_add_u32 s67, s66, s68
    s_waitcnt vmcnt(16)
    s_barrier
    s_mov_b32 m0, 114688
    s_nop 0
    buffer_load_dwordx4 v8, s[40:43], s66 offen  lds
    s_mov_b32 m0, 116736
    s_nop 0
    buffer_load_dwordx4 v9, s[40:43], s66 offen  lds
    s_mov_b32 m0, 118784
    s_nop 0
    buffer_load_dwordx4 v10, s[40:43], s66 offen  lds
    s_mov_b32 m0, 120832
    s_nop 0
    buffer_load_dwordx4 v11, s[40:43], s66 offen  lds
    s_mov_b32 m0, 115712
    s_nop 0
    buffer_load_dwordx4 v8, s[40:43], s67 offen  lds
    s_mov_b32 m0, 117760
    s_nop 0
    buffer_load_dwordx4 v9, s[40:43], s67 offen  lds
    s_mov_b32 m0, 119808
    s_nop 0
    buffer_load_dwordx4 v10, s[40:43], s67 offen  lds
    s_mov_b32 m0, 121856
    s_nop 0
    buffer_load_dwordx4 v11, s[40:43], s67 offen  lds
    s_add_u32 s66, s66, s63
    s_cmp_eq_u32 s66, s69
    s_cselect_b32 s66, 0, s66
    s_add_u32 s67, s66, s68
    s_waitcnt vmcnt(16)
    s_barrier
    s_mov_b32 m0, 65536
    s_nop 0
    buffer_load_dwordx4 v8, s[40:43], s66 offen  lds
    s_mov_b32 m0, 67584
    s_nop 0
    buffer_load_dwordx4 v9, s[40:43], s66 offen  lds
    s_mov_b32 m0, 69632
    s_nop 0
    buffer_load_dwordx4 v10, s[40:43], s66 offen  lds
    s_mov_b32 m0, 71680
    s_nop 0
    buffer_load_dwordx4 v11, s[40:43], s66 offen  lds
    s_mov_b32 m0, 66560
    s_nop 0
    buffer_load_dwordx4 v8, s[40:43], s67 offen  lds
    s_mov_b32 m0, 68608
    s_nop 0
    buffer_load_dwordx4 v9, s[40:43], s67 offen  lds
    s_mov_b32 m0, 70656
    s_nop 0
    buffer_load_dwordx4 v10, s[40:43], s67 offen  lds
    s_mov_b32 m0, 72704
    s_nop 0
    buffer_load_dwordx4 v11, s[40:43], s67 offen  lds
    s_add_u32 s66, s66, s63
    s_cmp_eq_u32 s66, s69
    s_cselect_b32 s66, 0, s66
    s_add_u32 s67, s66, s68
    s_waitcnt vmcnt(16)
    s_barrier
    s_mov_b32 m0, 81920
    s_nop 0
    buffer_load_dwordx4 v8, s[40:43], s66 offen  lds
    s_mov_b32 m0, 83968
    s_nop 0
    buffer_load_dwordx4 v9, s[40:43], s66 offen  lds
    s_mov_b32 m0, 86016
    s_nop 0
    buffer_load_dwordx4 v10, s[40:43], s66 offen  lds
    s_mov_b32 m0, 88064
    s_nop 0
    buffer_load_dwordx4 v11, s[40:43], s66 offen  lds
    s_mov_b32 m0, 82944
    s_nop 0
    buffer_load_dwordx4 v8, s[40:43], s67 offen  lds
    s_mov_b32 m0, 84992
    s_nop 0
    buffer_load_dwordx4 v9, s[40:43], s67 offen  lds
    s_mov_b32 m0, 87040
    s_nop 0
    buffer_load_dwordx4 v10, s[40:43], s67 offen  lds
    s_mov_b32 m0, 89088
    s_nop 0
    buffer_load_dwordx4 v11, s[40:43], s67 offen  lds
    s_add_u32 s66, s66, s63
    s_cmp_eq_u32 s66, s69
    s_cselect_b32 s66, 0, s66
    s_add_u32 s67, s66, s68
    s_waitcnt vmcnt(16)
    s_barrier
    s_mov_b32 m0, 98304
    s_nop 0
    buffer_load_dwordx4 v8, s[40:43], s66 offen  lds
    s_mov_b32 m0, 100352
    s_nop 0
    buffer_load_dwordx4 v9, s[40:43], s66 offen  lds
    s_mov_b32 m0, 102400
    s_nop 0
    buffer_load_dwordx4 v10, s[40:43], s66 offen  lds
    s_mov_b32 m0, 104448
    s_nop 0
    buffer_load_dwordx4 v11, s[40:43], s66 offen  lds
    s_mov_b32 m0, 99328
    s_nop 0
    buffer_load_dwordx4 v8, s[40:43], s67 offen  lds
    s_mov_b32 m0, 101376
    s_nop 0
    buffer_load_dwordx4 v9, s[40:43], s67 offen  lds
    s_mov_b32 m0, 103424
    s_nop 0
    buffer_load_dwordx4 v10, s[40:43], s67 offen  lds
    s_mov_b32 m0, 105472
    s_nop 0
    buffer_load_dwordx4 v11, s[40:43], s67 offen  lds
    s_add_u32 s66, s66, s63
    s_cmp_eq_u32 s66, s69
    s_cselect_b32 s66, 0, s66
    s_add_u32 s67, s66, s68
    s_waitcnt vmcnt(16)
    s_barrier
    s_mov_b32 m0, 114688
    s_nop 0
    buffer_load_dwordx4 v8, s[40:43], s66 offen  lds
    s_mov_b32 m0, 116736
    s_nop 0
    buffer_load_dwordx4 v9, s[40:43], s66 offen  lds
    s_mov_b32 m0, 118784
    s_nop 0
    buffer_load_dwordx4 v10, s[40:43], s66 offen  lds
    s_mov_b32 m0, 120832
    s_nop 0
    buffer_load_dwordx4 v11, s[40:43], s66 offen  lds
    s_mov_b32 m0, 115712
    s_nop 0
    buffer_load_dwordx4 v8, s[40:43], s67 offen  lds
    s_mov_b32 m0, 117760
    s_nop 0
    buffer_load_dwordx4 v9, s[40:43], s67 offen  lds
    s_mov_b32 m0, 119808
    s_nop 0
    buffer_load_dwordx4 v10, s[40:43], s67 offen  lds
    s_mov_b32 m0, 121856
    s_nop 0
    buffer_load_dwordx4 v11, s[40:43], s67 offen  lds
    s_add_u32 s66, s66, s63
    s_cmp_eq_u32 s66, s69
    s_cselect_b32 s66, 0, s66
    s_add_u32 s67, s66, s68
    s_waitcnt vmcnt(16)
    s_barrier
    s_waitcnt vmcnt(8)
    s_mov_b32 s56, 13713408
    buffer_load_dword v2, v232, s[44:47], s56 offen sc1
    s_barrier
    s_waitcnt vmcnt(1)
    s_barrier
    s_waitcnt vmcnt(0)
    s_mov_b32 s57, 0x40000
    s_lshl_b32 s58, s64, 1
L_wpl_21:
    v_cmp_gt_u32 s[88:89], s58, v1
    v_cmp_ne_u32 vcc, 1, v2
    s_nop 3
    s_and_b64 vcc, vcc, s[88:89]
    s_cbranch_vccz L_wpk_22
    s_mov_b32 s56, 13713408
    buffer_load_dword v2, v232, s[44:47], s56 offen sc1
    s_waitcnt vmcnt(0)
    s_sub_u32 s57, s57, 1
    s_cmp_lg_u32 s57, 0
    s_cbranch_scc1 L_wpl_21
L_wpk_22:
    v_lshlrev_b32 v4, 4, v1
    s_add_u32 s65, s82, 0
    s_sub_u32 s67, s65, s64
    s_cmp_ge_u32 s65, s64
    s_cselect_b32 s65, s67, s65
    s_mul_i32 s67, s65, 5120
    s_add_u32 s67, s67, s81
    s_add_u32 s68, s67, 4096
    buffer_load_dwordx4 v[136:139], v4, s[44:47], s67 offen offset:0 sc1
    buffer_load_dwordx4 v[140:143], v4, s[44:47], s67 offen offset:1024 sc1
    buffer_load_dwordx4 v[144:147], v4, s[44:47], s67 offen offset:2048 sc1
    buffer_load_dwordx4 v[148:151], v4, s[44:47], s67 offen offset:3072 sc1
    buffer_load_dwordx4 v[152:155], v4, s[44:47], s68 offen sc1
    s_add_u32 s65, s82, 1
    s_sub_u32 s67, s65, s64
    s_cmp_ge_u32 s65, s64
    s_cselect_b32 s65, s67, s65
    s_mul_i32 s67, s65, 5120
    s_add_u32 s67, s67, s81
    s_add_u32 s68, s67, 4096
    buffer_load_dwordx4 v[156:159], v4, s[44:47], s67 offen offset:0 sc1
    buffer_load_dwordx4 v[160:163], v4, s[44:47], s67 offen offset:1024 sc1
    buffer_load_dwordx4 v[164:167], v4, s[44:47], s67 offen offset:2048 sc1
    buffer_load_dwordx4 v[168:171], v4, s[44:47], s67 offen offset:3072 sc1
    buffer_load_dwordx4 v[172:175], v4, s[44:47], s68 offen sc1
    s_add_u32 s65, s82, 2
    s_sub_u32 s67, s65, s64
    s_cmp_ge_u32 s65, s64
    s_cselect_b32 s65, s67, s65
    s_mul_i32 s67, s65, 5120
    s_add_u32 s67, s67, s81
    s_add_u32 s68, s67, 4096
    buffer_load_dwordx4 v[176:179], v4, s[44:47], s67 offen offset:0 sc1
    buffer_load_dwordx4 v[180:183], v4, s[44:47], s67 offen offset:1024 sc1
    buffer_load_dwordx4 v[184:187], v4, s[44:47], s67 offen offset:2048 sc1
    buffer_load_dwordx4 v[188:191], v4, s[44:47], s67 offen offset:3072 sc1
    buffer_load_dwordx4 v[192:195], v4, s[44:47], s68 offen sc1
    s_add_u32 s65, s82, 3
    s_sub_u32 s67, s65, s64
    s_cmp_ge_u32 s65, s64
    s_cselect_b32 s65, s67, s65
    s_mul_i32 s67, s65, 5120
    s_add_u32 s67, s67, s81
    s_add_u32 s68, s67, 4096
    buffer_load_dwordx4 v[196:199], v4, s[44:47], s67 offen offset:0 sc1
    buffer_load_dwordx4 v[200:203], v4, s[44:47], s67 offen offset:1024 sc1
    buffer_load_dwordx4 v[204:207], v4, s[44:47], s67 offen offset:2048 sc1
    buffer_load_dwordx4 v[208:211], v4, s[44:47], s67 offen offset:3072 sc1
    buffer_load_dwordx4 v[212:215], v4, s[44:47], s68 offen sc1
    s_cmp_eq_u32 s33, 1
    s_cbranch_scc1 L_attn
    s_branch L_bar3
L_ldw1:
    s_and_b32 s100, s2, 1
    s_bfe_u32 s101, s2, 0x20001
    s_lshr_b32 s85, s2, 3
    s_cmp_lt_u32 s85, 18
    s_cselect_b32 s33, 1, 0
    s_cbranch_scc0 L_role_bw1
    s_mul_i32 s34, s100, 9
    s_lshr_b32 s58, s85, 1
    s_add_u32 s34, s34, s58
    s_lshl_b32 s35, s101, 1
    s_and_b32 s58, s85, 1
    s_add_u32 s35, s35, s58
    s_branch L_role_donew1
L_role_bw1:
    s_mul_i32 s58, s101, 14
    s_add_u32 s58, s58, s85
    s_sub_u32 s58, s58, 18
    s_lshr_b32 s35, s58, 3
    s_and_b32 s58, s58, 7
    s_lshl_b32 s34, s100, 3
    s_add_u32 s34, s34, s58
L_role_donew1:
    s_mul_i32 s58, s100, 9
    s_lshl_b32 s59, s100, 3
    s_cmp_eq_u32 s33, 1
    s_cselect_b32 s58, s58, s59
    s_sub_u32 s3, s34, s58
    s_and_b32 s58, s35, 1
    s_mul_i32 s58, s58, 5
    s_add_u32 s3, s3, s58
    s_cmp_eq_u32 s33, 1
    s_cselect_b32 s58, 0, 2
    s_add_u32 s3, s3, s58
    s_mul_i32 s58, s3, 205
    s_lshr_b32 s58, s58, 11
    s_mul_i32 s58, s58, 10
    s_sub_u32 s3, s3, s58
    s_and_b32 s56, s2, 7
    s_lshr_b32 s57, s2, 3
    s_lshl_b32 s78, s56, 2
    s_lshr_b32 s58, s57, 3
    s_add_u32 s78, s78, s58
    s_and_b32 s79, s57, 7
    s_and_b32 s83, s35, 1
    s_mul_i32 s76, s34, 114
    s_sub_u32 s76, s76, 14
    s_cmp_eq_u32 s33, 1
    s_mov_b32 s77, 3456
    s_cselect_b32 s77, 3840, s77
    s_lshl_b32 s58, s34, 3
    s_add_u32 s58, s58, s35
    s_mul_i32 s59, s34, 7
    s_add_u32 s59, s59, s35
    s_add_u32 s59, s59, 144
    s_cmp_eq_u32 s33, 1
    s_cselect_b32 s84, s58, s59
    v_lshrrev_b32 v2, 2, v1
    v_mul_lo_u32 v2, v2, s77
    v_and_b32 v3, 1, v1
    v_lshl_add_u32 v2, v3, 4, v2
    v_lshrrev_b32 v3, 1, v1
    v_lshrrev_b32 v4, 5, v1
    v_xor_b32 v3, v3, v4
    v_and_b32 v3, 1, v3
    v_cmp_eq_u32 vcc, 1, v3
    s_mul_i32 s60, s35, 160
    s_lshl_b32 s61, s83, 5
    s_add_u32 s61, s61, s60
    s_lshl_b32 s62, s35, 9
    s_lshl_b32 s63, s77, 5
    s_mul_i32 s66, s63, s3
    s_lshl_b32 s66, s66, 1
    s_lshl_b32 s68, s77, 4
    s_add_u32 s67, s66, s68
    s_mul_i32 s69, s63, 20
    s_add_u32 s56, s62, 256
    s_add_u32 s57, s56, 32
    s_add_u32 s58, s61, 2560
    s_add_u32 s59, s58, 32
    s_cmp_eq_u32 s33, 1
    s_cselect_b32 s56, s58, s56
    s_cselect_b32 s57, s59, s57
    v_mov_b32 v4, s56
    v_mov_b32 v5, s57
    v_cndmask_b32 v4, v4, v5, vcc
    v_add_u32 v8, v4, v2
    s_add_u32 s56, s62, 320
    s_add_u32 s57, s56, 32
    s_add_u32 s58, s61, 2624
    s_add_u32 s59, s58, 32
    s_cmp_eq_u32 s33, 1
    s_cselect_b32 s56, s58, s56
    s_cselect_b32 s57, s59, s57
    v_mov_b32 v4, s56
    v_mov_b32 v5, s57
    v_cndmask_b32 v4, v4, v5, vcc
    v_add_u32 v9, v4, v2
    s_add_u32 s56, s62, 384
    s_add_u32 s57, s56, 32
    s_cmp_ge_u32 s56, 3456
    s_cselect_b32 s56, 2147483648, s56
    s_cselect_b32 s57, 2147483648, s57
    s_cmp_eq_u32 s83, 1
    s_lshl_b32 s58, s83, 7
    s_sub_u32 s58, s60, s58
    s_add_u32 s58, s58, 128
    s_add_u32 s59, s58, 1280
    s_cmp_eq_u32 s33, 1
    s_cselect_b32 s56, s58, s56
    s_cselect_b32 s57, s59, s57
    v_mov_b32 v4, s56
    v_mov_b32 v5, s57
    v_cndmask_b32 v4, v4, v5, vcc
    v_add_u32 v10, v4, v2
    s_add_u32 s56, s62, 448
    s_add_u32 s57, s56, 32
    s_cmp_ge_u32 s56, 3456
    s_cselect_b32 s56, 2147483648, s56
    s_cselect_b32 s57, 2147483648, s57
    s_cmp_eq_u32 s83, 1
    s_lshl_b32 s58, s83, 7
    s_sub_u32 s58, s60, s58
    s_add_u32 s58, s58, 2688
    s_mov_b32 s59, 2147483648
    s_cmp_eq_u32 s33, 1
    s_cselect_b32 s56, s58, s56
    s_cselect_b32 s57, s59, s57
    v_mov_b32 v4, s56
    v_mov_b32 v5, s57
    v_cndmask_b32 v4, v4, v5, vcc
    v_add_u32 v11, v4, v2
    s_mov_b64 s[90:91], -1
    s_cmp_eq_u32 s33, 1
    s_cbranch_scc0 L_ng_24
    s_not_b64 s[90:91], vcc
L_ng_24:
    s_waitcnt lgkmcnt(0)
    s_mov_b32 s36, s8
    s_and_b32 s37, s9, 0xffff
    s_mov_b32 s38, 2621440
    s_mov_b32 s39, 0x20000
    s_cmp_eq_u32 s33, 1
    s_cselect_b32 s40, s10, s16
    s_cselect_b32 s56, s11, s17
    s_mov_b32 s42, 2211840
    s_cselect_b32 s42, 2457600, s42
    s_and_b32 s41, s56, 0xffff
    s_mov_b32 s43, 0x20000
    s_mov_b32 s44, s30
    s_and_b32 s45, s31, 0xffff
    s_mov_b32 s46, 14680064
    s_mov_b32 s47, 0x20000
    s_mov_b32 s96, s28
    s_and_b32 s97, s29, 0xffff
    s_mov_b32 s98, 256
    s_mov_b32 s99, 0x20000
    s_mov_b32 m0, 73728
    s_nop 0
    buffer_load_dwordx4 v8, s[40:43], s66 offen  lds
    s_mov_b32 m0, 75776
    s_nop 0
    buffer_load_dwordx4 v9, s[40:43], s66 offen  lds
    s_mov_b32 m0, 77824
    s_nop 0
    buffer_load_dwordx4 v10, s[40:43], s66 offen  lds
    s_mov_b64 exec, s[90:91]
    s_mov_b32 m0, 79872
    s_nop 0
    buffer_load_dwordx4 v11, s[40:43], s66 offen  lds
    s_mov_b64 exec, -1
    s_mov_b32 m0, 74752
    s_nop 0
    buffer_load_dwordx4 v8, s[40:43], s67 offen  lds
    s_mov_b32 m0, 76800
    s_nop 0
    buffer_load_dwordx4 v9, s[40:43], s67 offen  lds
    s_mov_b32 m0, 78848
    s_nop 0
    buffer_load_dwordx4 v10, s[40:43], s67 offen  lds
    s_mov_b64 exec, s[90:91]
    s_mov_b32 m0, 80896
    s_nop 0
    buffer_load_dwordx4 v11, s[40:43], s67 offen  lds
    s_mov_b64 exec, -1
    s_add_u32 s66, s66, s63
    s_cmp_eq_u32 s66, s69
    s_cselect_b32 s66, 0, s66
    s_add_u32 s67, s66, s68
    s_mov_b32 m0, 90112
    s_nop 0
    buffer_load_dwordx4 v8, s[40:43], s66 offen  lds
    s_mov_b32 m0, 92160
    s_nop 0
    buffer_load_dwordx4 v9, s[40:43], s66 offen  lds
    s_mov_b32 m0, 94208
    s_nop 0
    buffer_load_dwordx4 v10, s[40:43], s66 offen  lds
    s_mov_b64 exec, s[90:91]
    s_mov_b32 m0, 96256
    s_nop 0
    buffer_load_dwordx4 v11, s[40:43], s66 offen  lds
    s_mov_b64 exec, -1
    s_mov_b32 m0, 91136
    s_nop 0
    buffer_load_dwordx4 v8, s[40:43], s67 offen  lds
    s_mov_b32 m0, 93184
    s_nop 0
    buffer_load_dwordx4 v9, s[40:43], s67 offen  lds
    s_mov_b32 m0, 95232
    s_nop 0
    buffer_load_dwordx4 v10, s[40:43], s67 offen  lds
    s_mov_b64 exec, s[90:91]
    s_mov_b32 m0, 97280
    s_nop 0
    buffer_load_dwordx4 v11, s[40:43], s67 offen  lds
    s_mov_b64 exec, -1
    s_add_u32 s66, s66, s63
    s_cmp_eq_u32 s66, s69
    s_cselect_b32 s66, 0, s66
    s_add_u32 s67, s66, s68
    s_cmp_lt_u32 s32, 2
    s_cbranch_scc1 L_p3o_25
    s_add_u32 s56, s32, 2
    s_sub_u32 s57, s32, 4
    s_cmp_ge_u32 s32, 4
    s_cselect_b32 s56, s57, s56
    s_mul_i32 s58, s56, 9
    s_mul_i32 s80, s78, 54
    s_add_u32 s80, s80, s58
    s_lshl_b32 s80, s80, 12
    s_add_u32 s59, s58, 20
    s_mov_b32 s64, 9
    s_mov_b32 s62, 2147483648
    s_branch L_p3d_26
L_p3o_25:
    s_mul_i32 s59, s32, 10
    s_mul_i32 s80, s78, 20
    s_add_u32 s80, s80, s59
    s_lshl_b32 s80, s80, 12
    s_add_u32 s80, s80, 7340032
    s_mov_b32 s64, 10
    s_mov_b32 s62, 0
L_p3d_26:
    s_mul_i32 s81, s79, 74
    s_add_u32 s81, s81, s59
    s_mul_i32 s81, s81, 5120
    s_add_u32 s81, s81, 10485760
    s_mov_b32 s82, s79
    s_sub_u32 s60, s82, s64
    s_cmp_ge_u32 s82, s64
    s_cselect_b32 s82, s60, s82
    v_lshrrev_b32 v6, 1, v1
    v_add_u32 v6, s59, v6
    v_mul_u32_u24 v6, 10, v6
    s_mul_i32 s60, s79, 5
    s_lshr_b32 s60, s60, 2
    v_and_b32 v7, 1, v1
    v_add_u32 v6, v6, v7
    v_add_u32 v6, s60, v6
    v_mul_u32_u24 v7, 16384, v6
    v_lshrrev_b32 v7, 16, v7
    v_cmp_gt_u32 vcc, 448, v6
    v_subrev_u32 v6, 448, v6
    v_and_b32 v6, 0x3ff, v6
    v_mul_u32_u24 v6, 21846, v6
    v_lshrrev_b32 v6, 16, v6
    v_add_u32 v6, 112, v6
    v_cndmask_b32 v6, v6, v7, vcc
    v_lshlrev_b32 v6, 6, v6
    s_lshl_b32 s60, s64, 1
    v_cmp_gt_u32 vcc, s60, v1
    v_mov_b32 v7, 2147483648
    s_nop 0
    v_cndmask_b32 v232, v7, v6, vcc
    s_cmp_eq_u32 s33, 1
    s_cbranch_scc0 L_aa_27
    s_and_b32 s56, s32, 3
    s_lshr_b32 s57, s32, 2
    s_mul_i32 s58, s57, 31232
    s_mul_i32 s59, s56, 40
    s_add_u32 s58, s58, s59
    s_add_u32 s58, s58, 28864
    v_mul_u32_u24 v240, 488, v1
    v_add_u32 v240, s58, v240
    v_and_b32 v60, 48, v1
    v_and_b32 v61, 3, v1
    v_lshl_add_u32 v60, v61, 2, v60
    v_bfe_u32 v61, v1, 2, 2
    v_add_u32 v60, v60, v61
    v_mul_u32_u24 v241, 488, v60
    v_add_u32 v241, s58, v241
    s_mul_i32 s58, s57, 11264
    s_add_u32 s58, s58, s59
    s_add_u32 s58, s58, 133120
    v_mul_u32_u24 v242, 176, v1
    v_add_u32 v242, s58, v242
    s_add_u32 s56, s32, 0
    s_lshr_b32 s57, s56, 1
    s_and_b32 s56, s56, 1
    s_lshl_b32 s58, s56, 6
    v_add_u32 v60, s58, v1
    v_add_u32 v61, 14, v60
    v_and_b32 v62, 1, v61
    v_lshrrev_b32 v63, 1, v61
    v_lshl_add_u32 v62, v62, 6, v63
    v_min_u32 v62, 127, v62
    v_mul_u32_u24 v62, 176, v62
    s_lshl_b32 s59, s57, 4
    s_add_u32 s59, s59, 133120
    v_add_u32 v243, s59, v62
    s_add_u32 s59, s76, 14
    v_add_u32 v63, s59, v60
    s_mul_i32 s60, s35, 10
    s_add_u32 s60, s60, s57
    s_lshr_b32 s61, s60, 2
    s_and_b32 s60, s60, 3
    s_lshl_b32 s61, s61, 12
    s_lshl_b32 s60, s60, 8
    s_add_u32 s61, s61, s60
    s_add_u32 s71, s61, 7340032
    v_lshrrev_b32 v64, 6, v63
    v_mul_u32_u24 v64, 81920, v64
    v_bfe_u32 v65, v63, 4, 2
    v_lshl_add_u32 v64, v65, 10, v64
    v_and_b32 v65, 15, v63
    v_lshl_add_u32 v64, v65, 4, v64
    v_cmp_gt_u32 vcc, 114, v60
    s_nop 3
    s_mov_b64 s[88:89], vcc
    v_cmp_gt_u32 vcc, 2048, v63
    s_nop 3
    s_and_b64 vcc, vcc, s[88:89]
    v_mov_b32 v65, 2147483648
    s_nop 1
    v_cndmask_b32 v244, v65, v64, vcc
    s_add_u32 s56, s32, 8
    s_lshr_b32 s57, s56, 1
    s_and_b32 s56, s56, 1
    s_lshl_b32 s58, s56, 6
    v_add_u32 v60, s58, v1
    v_add_u32 v61, 14, v60
    v_and_b32 v62, 1, v61
    v_lshrrev_b32 v63, 1, v61
    v_lshl_add_u32 v62, v62, 6, v63
    v_min_u32 v62, 127, v62
    v_mul_u32_u24 v62, 176, v62
    s_lshl_b32 s59, s57, 4
    s_add_u32 s59, s59, 133120
    v_add_u32 v245, s59, v62
    s_add_u32 s59, s76, 14
    v_add_u32 v63, s59, v60
    s_mul_i32 s60, s35, 10
    s_add_u32 s60, s60, s57
    s_lshr_b32 s61, s60, 2
    s_and_b32 s60, s60, 3
    s_lshl_b32 s61, s61, 12
    s_lshl_b32 s60, s60, 8
    s_add_u32 s61, s61, s60
    s_add_u32 s72, s61, 7340032
    v_lshrrev_b32 v64, 6, v63
    v_mul_u32_u24 v64, 81920, v64
    v_bfe_u32 v65, v63, 4, 2
    v_lshl_add_u32 v64, v65, 10, v64
    v_and_b32 v65, 15, v63
    v_lshl_add_u32 v64, v65, 4, v64
    v_cmp_gt_u32 vcc, 114, v60
    s_nop 3
    s_mov_b64 s[88:89], vcc
    v_cmp_gt_u32 vcc, 2048, v63
    s_nop 3
    s_and_b64 vcc, vcc, s[88:89]
    v_mov_b32 v65, 2147483648
    s_nop 1
    v_cndmask_b32 v246, v65, v64, vcc
    s_add_u32 s56, s32, 16
    s_lshr_b32 s57, s56, 1
    s_and_b32 s56, s56, 1
    s_lshl_b32 s58, s56, 6
    v_add_u32 v60, s58, v1
    v_add_u32 v61, 14, v60
    v_and_b32 v62, 1, v61
    v_lshrrev_b32 v63, 1, v61
    v_lshl_add_u32 v62, v62, 6, v63
    v_min_u32 v62, 127, v62
    v_mul_u32_u24 v62, 176, v62
    s_lshl_b32 s59, s57, 4
    s_add_u32 s59, s59, 133120
    v_add_u32 v247, s59, v62
    s_add_u32 s59, s76, 14
    v_add_u32 v63, s59, v60
    s_mul_i32 s60, s35, 10
    s_add_u32 s60, s60, s57
    s_lshr_b32 s61, s60, 2
    s_and_b32 s60, s60, 3
    s_lshl_b32 s61, s61, 12
    s_lshl_b32 s60, s60, 8
    s_add_u32 s61, s61, s60
    s_add_u32 s73, s61, 7340032
    v_lshrrev_b32 v64, 6, v63
    v_mul_u32_u24 v64, 81920, v64
    v_bfe_u32 v65, v63, 4, 2
    v_lshl_add_u32 v64, v65, 10, v64
    v_and_b32 v65, 15, v63
    v_lshl_add_u32 v64, v65, 4, v64
    v_cmp_gt_u32 vcc, 114, v60
    s_nop 3
    s_mov_b64 s[88:89], vcc
    v_cmp_gt_u32 vcc, 2048, v63
    s_nop 3
    s_and_b64 vcc, vcc, s[88:89]
    v_mov_b32 v65, 2147483648
    s_nop 1
    v_cndmask_b32 v248, v65, v64, vcc
L_aa_27:
    s_waitcnt vmcnt(8)
    s_barrier
    s_mov_b32 m0, 106496
    s_nop 0
    buffer_load_dwordx4 v8, s[40:43], s66 offen  lds
    s_mov_b32 m0, 108544
    s_nop 0
    buffer_load_dwordx4 v9, s[40:43], s66 offen  lds
    s_mov_b32 m0, 110592
    s_nop 0
    buffer_load_dwordx4 v10, s[40:43], s66 offen  lds
    s_mov_b64 exec, s[90:91]
    s_mov_b32 m0, 112640
    s_nop 0
    buffer_load_dwordx4 v11, s[40:43], s66 offen  lds
    s_mov_b64 exec, -1
    s_mov_b32 m0, 107520
    s_nop 0
    buffer_load_dwordx4 v8, s[40:43], s67 offen  lds
    s_mov_b32 m0, 109568
    s_nop 0
    buffer_load_dwordx4 v9, s[40:43], s67 offen  lds
    s_mov_b32 m0, 111616
    s_nop 0
    buffer_load_dwordx4 v10, s[40:43], s67 offen  lds
    s_mov_b64 exec, s[90:91]
    s_mov_b32 m0, 113664
    s_nop 0
    buffer_load_dwordx4 v11, s[40:43], s67 offen  lds
    s_mov_b64 exec, -1
    s_add_u32 s66, s66, s63
    s_cmp_eq_u32 s66, s69
    s_cselect_b32 s66, 0, s66
    s_add_u32 s67, s66, s68
    s_mov_b32 m0, 122880
    s_nop 0
    buffer_load_dwordx4 v8, s[40:43], s66 offen  lds
    s_mov_b32 m0, 124928
    s_nop 0
    buffer_load_dwordx4 v9, s[40:43], s66 offen  lds
    s_mov_b32 m0, 126976
    s_nop 0
    buffer_load_dwordx4 v10, s[40:43], s66 offen  lds
    s_mov_b64 exec, s[90:91]
    s_mov_b32 m0, 129024
    s_nop 0
    buffer_load_dwordx4 v11, s[40:43], s66 offen  lds
    s_mov_b64 exec, -1
    s_mov_b32 m0, 123904
    s_nop 0
    buffer_load_dwordx4 v8, s[40:43], s67 offen  lds
    s_mov_b32 m0, 125952
    s_nop 0
    buffer_load_dwordx4 v9, s[40:43], s67 offen  lds
    s_mov_b32 m0, 128000
    s_nop 0
    buffer_load_dwordx4 v10, s[40:43], s67 offen  lds
    s_mov_b64 exec, s[90:91]
    s_mov_b32 m0, 130048
    s_nop 0
    buffer_load_dwordx4 v11, s[40:43], s67 offen  lds
    s_mov_b64 exec, -1
    s_add_u32 s66, s66, s63
    s_cmp_eq_u32 s66, s69
    s_cselect_b32 s66, 0, s66
    s_add_u32 s67, s66, s68
    s_waitcnt vmcnt(16)
    s_barrier
    s_mov_b32 m0, 73728
    s_nop 0
    buffer_load_dwordx4 v8, s[40:43], s66 offen  lds
    s_mov_b32 m0, 75776
    s_nop 0
    buffer_load_dwordx4 v9, s[40:43], s66 offen  lds
    s_mov_b32 m0, 77824
    s_nop 0
    buffer_load_dwordx4 v10, s[40:43], s66 offen  lds
    s_mov_b64 exec, s[90:91]
    s_mov_b32 m0, 79872
    s_nop 0
    buffer_load_dwordx4 v11, s[40:43], s66 offen  lds
    s_mov_b64 exec, -1
    s_mov_b32 m0, 74752
    s_nop 0
    buffer_load_dwordx4 v8, s[40:43], s67 offen  lds
    s_mov_b32 m0, 76800
    s_nop 0
    buffer_load_dwordx4 v9, s[40:43], s67 offen  lds
    s_mov_b32 m0, 78848
    s_nop 0
    buffer_load_dwordx4 v10, s[40:43], s67 offen  lds
    s_mov_b64 exec, s[90:91]
    s_mov_b32 m0, 80896
    s_nop 0
    buffer_load_dwordx4 v11, s[40:43], s67 offen  lds
    s_mov_b64 exec, -1
    s_add_u32 s66, s66, s63
    s_cmp_eq_u32 s66, s69
    s_cselect_b32 s66, 0, s66
    s_add_u32 s67, s66, s68
    s_waitcnt vmcnt(16)
    s_barrier
    s_mov_b32 m0, 90112
    s_nop 0
    buffer_load_dwordx4 v8, s[40:43], s66 offen  lds
    s_mov_b32 m0, 92160
    s_nop 0
    buffer_load_dwordx4 v9, s[40:43], s66 offen  lds
    s_mov_b32 m0, 94208
    s_nop 0
    buffer_load_dwordx4 v10, s[40:43], s66 offen  lds
    s_mov_b64 exec, s[90:91]
    s_mov_b32 m0, 96256
    s_nop 0
    buffer_load_dwordx4 v11, s[40:43], s66 offen  lds
    s_mov_b64 exec, -1
    s_mov_b32 m0, 91136
    s_nop 0
    buffer_load_dwordx4 v8, s[40:43], s67 offen  lds
    s_mov_b32 m0, 93184
    s_nop 0
    buffer_load_dwordx4 v9, s[40:43], s67 offen  lds
    s_mov_b32 m0, 95232
    s_nop 0
    buffer_load_dwordx4 v10, s[40:43], s67 offen  lds
    s_mov_b64 exec, s[90:91]
    s_mov_b32 m0, 97280
    s_nop 0
    buffer_load_dwordx4 v11, s[40:43], s67 offen  lds
    s_mov_b64 exec, -1
    s_add_u32 s66, s66, s63
    s_cmp_eq_u32 s66, s69
    s_cselect_b32 s66, 0, s66
    s_add_u32 s67, s66, s68
    s_waitcnt vmcnt(16)
    s_barrier
    s_mov_b32 m0, 106496
    s_nop 0
    buffer_load_dwordx4 v8, s[40:43], s66 offen  lds
    s_mov_b32 m0, 108544
    s_nop 0
    buffer_load_dwordx4 v9, s[40:43], s66 offen  lds
    s_mov_b32 m0, 110592
    s_nop 0
    buffer_load_dwordx4 v10, s[40:43], s66 offen  lds
    s_mov_b64 exec, s[90:91]
    s_mov_b32 m0, 112640
    s_nop 0
    buffer_load_dwordx4 v11, s[40:43], s66 offen  lds
    s_mov_b64 exec, -1
    s_mov_b32 m0, 107520
    s_nop 0
    buffer_load_dwordx4 v8, s[40:43], s67 offen  lds
    s_mov_b32 m0, 109568
    s_nop 0
    buffer_load_dwordx4 v9, s[40:43], s67 offen  lds
    s_mov_b32 m0, 111616
    s_nop 0
    buffer_load_dwordx4 v10, s[40:43], s67 offen  lds
    s_mov_b64 exec, s[90:91]
    s_mov_b32 m0, 113664
    s_nop 0
    buffer_load_dwordx4 v11, s[40:43], s67 offen  lds
    s_mov_b64 exec, -1
    s_add_u32 s66, s66, s63
    s_cmp_eq_u32 s66, s69
    s_cselect_b32 s66, 0, s66
    s_add_u32 s67, s66, s68
    s_waitcnt vmcnt(16)
    s_barrier
    s_mov_b32 m0, 122880
    s_nop 0
    buffer_load_dwordx4 v8, s[40:43], s66 offen  lds
    s_mov_b32 m0, 124928
    s_nop 0
    buffer_load_dwordx4 v9, s[40:43], s66 offen  lds
    s_mov_b32 m0, 126976
    s_nop 0
    buffer_load_dwordx4 v10, s[40:43], s66 offen  lds
    s_mov_b64 exec, s[90:91]
    s_mov_b32 m0, 129024
    s_nop 0
    buffer_load_dwordx4 v11, s[40:43], s66 offen  lds
    s_mov_b64 exec, -1
    s_mov_b32 m0, 123904
    s_nop 0
    buffer_load_dwordx4 v8, s[40:43], s67 offen  lds
    s_mov_b32 m0, 125952
    s_nop 0
    buffer_load_dwordx4 v9, s[40:43], s67 offen  lds
    s_mov_b32 m0, 128000
    s_nop 0
    buffer_load_dwordx4 v10, s[40:43], s67 offen  lds
    s_mov_b64 exec, s[90:91]
    s_mov_b32 m0, 130048
    s_nop 0
    buffer_load_dwordx4 v11, s[40:43], s67 offen  lds
    s_mov_b64 exec, -1
    s_add_u32 s66, s66, s63
    s_cmp_eq_u32 s66, s69
    s_cselect_b32 s66, 0, s66
    s_add_u32 s67, s66, s68
    s_waitcnt vmcnt(16)
    s_barrier
    s_mov_b32 m0, 73728
    s_nop 0
    buffer_load_dwordx4 v8, s[40:43], s66 offen  lds
    s_mov_b32 m0, 75776
    s_nop 0
    buffer_load_dwordx4 v9, s[40:43], s66 offen  lds
    s_mov_b32 m0, 77824
    s_nop 0
    buffer_load_dwordx4 v10, s[40:43], s66 offen  lds
    s_mov_b64 exec, s[90:91]
    s_mov_b32 m0, 79872
    s_nop 0
    buffer_load_dwordx4 v11, s[40:43], s66 offen  lds
    s_mov_b64 exec, -1
    s_mov_b32 m0, 74752
    s_nop 0
    buffer_load_dwordx4 v8, s[40:43], s67 offen  lds
    s_mov_b32 m0, 76800
    s_nop 0
    buffer_load_dwordx4 v9, s[40:43], s67 offen  lds
    s_mov_b32 m0, 78848
    s_nop 0
    buffer_load_dwordx4 v10, s[40:43], s67 offen  lds
    s_mov_b64 exec, s[90:91]
    s_mov_b32 m0, 80896
    s_nop 0
    buffer_load_dwordx4 v11, s[40:43], s67 offen  lds
    s_mov_b64 exec, -1
    s_add_u32 s66, s66, s63
    s_cmp_eq_u32 s66, s69
    s_cselect_b32 s66, 0, s66
    s_add_u32 s67, s66, s68
    s_waitcnt vmcnt(16)
    s_barrier
    s_mov_b32 m0, 90112
    s_nop 0
    buffer_load_dwordx4 v8, s[40:43], s66 offen  lds
    s_mov_b32 m0, 92160
    s_nop 0
    buffer_load_dwordx4 v9, s[40:43], s66 offen  lds
    s_mov_b32 m0, 94208
    s_nop 0
    buffer_load_dwordx4 v10, s[40:43], s66 offen  lds
    s_mov_b64 exec, s[90:91]
    s_mov_b32 m0, 96256
    s_nop 0
    buffer_load_dwordx4 v11, s[40:43], s66 offen  lds
    s_mov_b64 exec, -1
    s_mov_b32 m0, 91136
    s_nop 0
    buffer_load_dwordx4 v8, s[40:43], s67 offen  lds
    s_mov_b32 m0, 93184
    s_nop 0
    buffer_load_dwordx4 v9, s[40:43], s67 offen  lds
    s_mov_b32 m0, 95232
    s_nop 0
    buffer_load_dwordx4 v10, s[40:43], s67 offen  lds
    s_mov_b64 exec, s[90:91]
    s_mov_b32 m0, 97280
    s_nop 0
    buffer_load_dwordx4 v11, s[40:43], s67 offen  lds
    s_mov_b64 exec, -1
    s_add_u32 s66, s66, s63
    s_cmp_eq_u32 s66, s69
    s_cselect_b32 s66, 0, s66
    s_add_u32 s67, s66, s68
    s_waitcnt vmcnt(16)
    s_barrier
    s_mov_b32 m0, 106496
    s_nop 0
    buffer_load_dwordx4 v8, s[40:43], s66 offen  lds
    s_mov_b32 m0, 108544
    s_nop 0
    buffer_load_dwordx4 v9, s[40:43], s66 offen  lds
    s_mov_b32 m0, 110592
    s_nop 0
    buffer_load_dwordx4 v10, s[40:43], s66 offen  lds
    s_mov_b64 exec, s[90:91]
    s_mov_b32 m0, 112640
    s_nop 0
    buffer_load_dwordx4 v11, s[40:43], s66 offen  lds
    s_mov_b64 exec, -1
    s_mov_b32 m0, 107520
    s_nop 0
    buffer_load_dwordx4 v8, s[40:43], s67 offen  lds
    s_mov_b32 m0, 109568
    s_nop 0
    buffer_load_dwordx4 v9, s[40:43], s67 offen  lds
    s_mov_b32 m0, 111616
    s_nop 0
    buffer_load_dwordx4 v10, s[40:43], s67 offen  lds
    s_mov_b64 exec, s[90:91]
    s_mov_b32 m0, 113664
    s_nop 0
    buffer_load_dwordx4 v11, s[40:43], s67 offen  lds
    s_mov_b64 exec, -1
    s_add_u32 s66, s66, s63
    s_cmp_eq_u32 s66, s69
    s_cselect_b32 s66, 0, s66
    s_add_u32 s67, s66, s68
    s_waitcnt vmcnt(16)
    s_barrier
    s_mov_b32 m0, 122880
    s_nop 0
    buffer_load_dwordx4 v8, s[40:43], s66 offen  lds
    s_mov_b32 m0, 124928
    s_nop 0
    buffer_load_dwordx4 v9, s[40:43], s66 offen  lds
    s_mov_b32 m0, 126976
    s_nop 0
    buffer_load_dwordx4 v10, s[40:43], s66 offen  lds
    s_mov_b64 exec, s[90:91]
    s_mov_b32 m0, 129024
    s_nop 0
    buffer_load_dwordx4 v11, s[40:43], s66 offen  lds
    s_mov_b64 exec, -1
    s_mov_b32 m0, 123904
    s_nop 0
    buffer_load_dwordx4 v8, s[40:43], s67 offen  lds
    s_mov_b32 m0, 125952
    s_nop 0
    buffer_load_dwordx4 v9, s[40:43], s67 offen  lds
    s_mov_b32 m0, 128000
    s_nop 0
    buffer_load_dwordx4 v10, s[40:43], s67 offen  lds
    s_mov_b64 exec, s[90:91]
    s_mov_b32 m0, 130048
    s_nop 0
    buffer_load_dwordx4 v11, s[40:43], s67 offen  lds
    s_mov_b64 exec, -1
    s_add_u32 s66, s66, s63
    s_cmp_eq_u32 s66, s69
    s_cselect_b32 s66, 0, s66
    s_add_u32 s67, s66, s68
    s_waitcnt vmcnt(16)
    s_barrier
    s_mov_b32 m0, 73728
    s_nop 0
    buffer_load_dwordx4 v8, s[40:43], s66 offen  lds
    s_mov_b32 m0, 75776
    s_nop 0
    buffer_load_dwordx4 v9, s[40:43], s66 offen  lds
    s_mov_b32 m0, 77824
    s_nop 0
    buffer_load_dwordx4 v10, s[40:43], s66 offen  lds
    s_mov_b64 exec, s[90:91]
    s_mov_b32 m0, 79872
    s_nop 0
    buffer_load_dwordx4 v11, s[40:43], s66 offen  lds
    s_mov_b64 exec, -1
    s_mov_b32 m0, 74752
    s_nop 0
    buffer_load_dwordx4 v8, s[40:43], s67 offen  lds
    s_mov_b32 m0, 76800
    s_nop 0
    buffer_load_dwordx4 v9, s[40:43], s67 offen  lds
    s_mov_b32 m0, 78848
    s_nop 0
    buffer_load_dwordx4 v10, s[40:43], s67 offen  lds
    s_mov_b64 exec, s[90:91]
    s_mov_b32 m0, 80896
    s_nop 0
    buffer_load_dwordx4 v11, s[40:43], s67 offen  lds
    s_mov_b64 exec, -1
    s_add_u32 s66, s66, s63
    s_cmp_eq_u32 s66, s69
    s_cselect_b32 s66, 0, s66
    s_add_u32 s67, s66, s68
    s_waitcnt vmcnt(16)
    s_barrier
    s_mov_b32 m0, 90112
    s_nop 0
    buffer_load_dwordx4 v8, s[40:43], s66 offen  lds
    s_mov_b32 m0, 92160
    s_nop 0
    buffer_load_dwordx4 v9, s[40:43], s66 offen  lds
    s_mov_b32 m0, 94208
    s_nop 0
    buffer_load_dwordx4 v10, s[40:43], s66 offen  lds
    s_mov_b64 exec, s[90:91]
    s_mov_b32 m0, 96256
    s_nop 0
    buffer_load_dwordx4 v11, s[40:43], s66 offen  lds
    s_mov_b64 exec, -1
    s_mov_b32 m0, 91136
    s_nop 0
    buffer_load_dwordx4 v8, s[40:43], s67 offen  lds
    s_mov_b32 m0, 93184
    s_nop 0
    buffer_load_dwordx4 v9, s[40:43], s67 offen  lds
    s_mov_b32 m0, 95232
    s_nop 0
    buffer_load_dwordx4 v10, s[40:43], s67 offen  lds
    s_mov_b64 exec, s[90:91]
    s_mov_b32 m0, 97280
    s_nop 0
    buffer_load_dwordx4 v11, s[40:43], s67 offen  lds
    s_mov_b64 exec, -1
    s_add_u32 s66, s66, s63
    s_cmp_eq_u32 s66, s69
    s_cselect_b32 s66, 0, s66
    s_add_u32 s67, s66, s68
    s_waitcnt vmcnt(16)
    s_barrier
    s_mov_b32 m0, 106496
    s_nop 0
    buffer_load_dwordx4 v8, s[40:43], s66 offen  lds
    s_mov_b32 m0, 108544
    s_nop 0
    buffer_load_dwordx4 v9, s[40:43], s66 offen  lds
    s_mov_b32 m0, 110592
    s_nop 0
    buffer_load_dwordx4 v10, s[40:43], s66 offen  lds
    s_mov_b64 exec, s[90:91]
    s_mov_b32 m0, 112640
    s_nop 0
    buffer_load_dwordx4 v11, s[40:43], s66 offen  lds
    s_mov_b64 exec, -1
    s_mov_b32 m0, 107520
    s_nop 0
    buffer_load_dwordx4 v8, s[40:43], s67 offen  lds
    s_mov_b32 m0, 109568
    s_nop 0
    buffer_load_dwordx4 v9, s[40:43], s67 offen  lds
    s_mov_b32 m0, 111616
    s_nop 0
    buffer_load_dwordx4 v10, s[40:43], s67 offen  lds
    s_mov_b64 exec, s[90:91]
    s_mov_b32 m0, 113664
    s_nop 0
    buffer_load_dwordx4 v11, s[40:43], s67 offen  lds
    s_mov_b64 exec, -1
    s_add_u32 s66, s66, s63
    s_cmp_eq_u32 s66, s69
    s_cselect_b32 s66, 0, s66
    s_add_u32 s67, s66, s68
    s_waitcnt vmcnt(16)
    s_barrier
    s_mov_b32 m0, 122880
    s_nop 0
    buffer_load_dwordx4 v8, s[40:43], s66 offen  lds
    s_mov_b32 m0, 124928
    s_nop 0
    buffer_load_dwordx4 v9, s[40:43], s66 offen  lds
    s_mov_b32 m0, 126976
    s_nop 0
    buffer_load_dwordx4 v10, s[40:43], s66 offen  lds
    s_mov_b64 exec, s[90:91]
    s_mov_b32 m0, 129024
    s_nop 0
    buffer_load_dwordx4 v11, s[40:43], s66 offen  lds
    s_mov_b64 exec, -1
    s_mov_b32 m0, 123904
    s_nop 0
    buffer_load_dwordx4 v8, s[40:43], s67 offen  lds
    s_mov_b32 m0, 125952
    s_nop 0
    buffer_load_dwordx4 v9, s[40:43], s67 offen  lds
    s_mov_b32 m0, 128000
    s_nop 0
    buffer_load_dwordx4 v10, s[40:43], s67 offen  lds
    s_mov_b64 exec, s[90:91]
    s_mov_b32 m0, 130048
    s_nop 0
    buffer_load_dwordx4 v11, s[40:43], s67 offen  lds
    s_mov_b64 exec, -1
    s_add_u32 s66, s66, s63
    s_cmp_eq_u32 s66, s69
    s_cselect_b32 s66, 0, s66
    s_add_u32 s67, s66, s68
    s_waitcnt vmcnt(16)
    s_barrier
    s_mov_b32 m0, 73728
    s_nop 0
    buffer_load_dwordx4 v8, s[40:43], s66 offen  lds
    s_mov_b32 m0, 75776
    s_nop 0
    buffer_load_dwordx4 v9, s[40:43], s66 offen  lds
    s_mov_b32 m0, 77824
    s_nop 0
    buffer_load_dwordx4 v10, s[40:43], s66 offen  lds
    s_mov_b64 exec, s[90:91]
    s_mov_b32 m0, 79872
    s_nop 0
    buffer_load_dwordx4 v11, s[40:43], s66 offen  lds
    s_mov_b64 exec, -1
    s_mov_b32 m0, 74752
    s_nop 0
    buffer_load_dwordx4 v8, s[40:43], s67 offen  lds
    s_mov_b32 m0, 76800
    s_nop 0
    buffer_load_dwordx4 v9, s[40:43], s67 offen  lds
    s_mov_b32 m0, 78848
    s_nop 0
    buffer_load_dwordx4 v10, s[40:43], s67 offen  lds
    s_mov_b64 exec, s[90:91]
    s_mov_b32 m0, 80896
    s_nop 0
    buffer_load_dwordx4 v11, s[40:43], s67 offen  lds
    s_mov_b64 exec, -1
    s_add_u32 s66, s66, s63
    s_cmp_eq_u32 s66, s69
    s_cselect_b32 s66, 0, s66
    s_add_u32 s67, s66, s68
    s_waitcnt vmcnt(16)
    s_barrier
    s_mov_b32 m0, 90112
    s_nop 0
    buffer_load_dwordx4 v8, s[40:43], s66 offen  lds
    s_mov_b32 m0, 92160
    s_nop 0
    buffer_load_dwordx4 v9, s[40:43], s66 offen  lds
    s_mov_b32 m0, 94208
    s_nop 0
    buffer_load_dwordx4 v10, s[40:43], s66 offen  lds
    s_mov_b64 exec, s[90:91]
    s_mov_b32 m0, 96256
    s_nop 0
    buffer_load_dwordx4 v11, s[40:43], s66 offen  lds
    s_mov_b64 exec, -1
    s_mov_b32 m0, 91136
    s_nop 0
    buffer_load_dwordx4 v8, s[40:43], s67 offen  lds
    s_mov_b32 m0, 93184
    s_nop 0
    buffer_load_dwordx4 v9, s[40:43], s67 offen  lds
    s_mov_b32 m0, 95232
    s_nop 0
    buffer_load_dwordx4 v10, s[40:43], s67 offen  lds
    s_mov_b64 exec, s[90:91]
    s_mov_b32 m0, 97280
    s_nop 0
    buffer_load_dwordx4 v11, s[40:43], s67 offen  lds
    s_mov_b64 exec, -1
    s_add_u32 s66, s66, s63
    s_cmp_eq_u32 s66, s69
    s_cselect_b32 s66, 0, s66
    s_add_u32 s67, s66, s68
    s_waitcnt vmcnt(16)
    s_barrier
    s_mov_b32 m0, 106496
    s_nop 0
    buffer_load_dwordx4 v8, s[40:43], s66 offen  lds
    s_mov_b32 m0, 108544
    s_nop 0
    buffer_load_dwordx4 v9, s[40:43], s66 offen  lds
    s_mov_b32 m0, 110592
    s_nop 0
    buffer_load_dwordx4 v10, s[40:43], s66 offen  lds
    s_mov_b64 exec, s[90:91]
    s_mov_b32 m0, 112640
    s_nop 0
    buffer_load_dwordx4 v11, s[40:43], s66 offen  lds
    s_mov_b64 exec, -1
    s_mov_b32 m0, 107520
    s_nop 0
    buffer_load_dwordx4 v8, s[40:43], s67 offen  lds
    s_mov_b32 m0, 109568
    s_nop 0
    buffer_load_dwordx4 v9, s[40:43], s67 offen  lds
    s_mov_b32 m0, 111616
    s_nop 0
    buffer_load_dwordx4 v10, s[40:43], s67 offen  lds
    s_mov_b64 exec, s[90:91]
    s_mov_b32 m0, 113664
    s_nop 0
    buffer_load_dwordx4 v11, s[40:43], s67 offen  lds
    s_mov_b64 exec, -1
    s_add_u32 s66, s66, s63
    s_cmp_eq_u32 s66, s69
    s_cselect_b32 s66, 0, s66
    s_add_u32 s67, s66, s68
    s_waitcnt vmcnt(16)
    s_barrier
    s_mov_b32 m0, 122880
    s_nop 0
    buffer_load_dwordx4 v8, s[40:43], s66 offen  lds
    s_mov_b32 m0, 124928
    s_nop 0
    buffer_load_dwordx4 v9, s[40:43], s66 offen  lds
    s_mov_b32 m0, 126976
    s_nop 0
    buffer_load_dwordx4 v10, s[40:43], s66 offen  lds
    s_mov_b64 exec, s[90:91]
    s_mov_b32 m0, 129024
    s_nop 0
    buffer_load_dwordx4 v11, s[40:43], s66 offen  lds
    s_mov_b64 exec, -1
    s_mov_b32 m0, 123904
    s_nop 0
    buffer_load_dwordx4 v8, s[40:43], s67 offen  lds
    s_mov_b32 m0, 125952
    s_nop 0
    buffer_load_dwordx4 v9, s[40:43], s67 offen  lds
    s_mov_b32 m0, 128000
    s_nop 0
    buffer_load_dwordx4 v10, s[40:43], s67 offen  lds
    s_mov_b64 exec, s[90:91]
    s_mov_b32 m0, 130048
    s_nop 0
    buffer_load_dwordx4 v11, s[40:43], s67 offen  lds
    s_mov_b64 exec, -1
    s_add_u32 s66, s66, s63
    s_cmp_eq_u32 s66, s69
    s_cselect_b32 s66, 0, s66
    s_add_u32 s67, s66, s68
    s_waitcnt vmcnt(16)
    s_barrier
    s_waitcnt vmcnt(8)
    s_mov_b32 s56, 13713408
    buffer_load_dword v2, v232, s[44:47], s56 offen sc1
    s_barrier
    s_waitcnt vmcnt(1)
    s_barrier
    s_waitcnt vmcnt(0)
    s_mov_b32 s57, 0x40000
    s_lshl_b32 s58, s64, 1
L_wpl_28:
    v_cmp_gt_u32 s[88:89], s58, v1
    v_cmp_ne_u32 vcc, 1, v2
    s_nop 3
    s_and_b64 vcc, vcc, s[88:89]
    s_cbranch_vccz L_wpk_29
    s_mov_b32 s56, 13713408
    buffer_load_dword v2, v232, s[44:47], s56 offen sc1
    s_waitcnt vmcnt(0)
    s_sub_u32 s57, s57, 1
    s_cmp_lg_u32 s57, 0
    s_cbranch_scc1 L_wpl_28
L_wpk_29:
    v_lshlrev_b32 v4, 4, v1
    s_add_u32 s65, s82, 0
    s_sub_u32 s67, s65, s64
    s_cmp_ge_u32 s65, s64
    s_cselect_b32 s65, s67, s65
    s_mul_i32 s67, s65, 5120
    s_add_u32 s67, s67, s81
    s_add_u32 s68, s67, 4096
    buffer_load_dwordx4 v[136:139], v4, s[44:47], s67 offen offset:0 sc1
    buffer_load_dwordx4 v[140:143], v4, s[44:47], s67 offen offset:1024 sc1
    buffer_load_dwordx4 v[144:147], v4, s[44:47], s67 offen offset:2048 sc1
    buffer_load_dwordx4 v[148:151], v4, s[44:47], s67 offen offset:3072 sc1
    buffer_load_dwordx4 v[152:155], v4, s[44:47], s68 offen sc1
    s_add_u32 s65, s82, 1
    s_sub_u32 s67, s65, s64
    s_cmp_ge_u32 s65, s64
    s_cselect_b32 s65, s67, s65
    s_mul_i32 s67, s65, 5120
    s_add_u32 s67, s67, s81
    s_add_u32 s68, s67, 4096
    buffer_load_dwordx4 v[156:159], v4, s[44:47], s67 offen offset:0 sc1
    buffer_load_dwordx4 v[160:163], v4, s[44:47], s67 offen offset:1024 sc1
    buffer_load_dwordx4 v[164:167], v4, s[44:47], s67 offen offset:2048 sc1
    buffer_load_dwordx4 v[168:171], v4, s[44:47], s67 offen offset:3072 sc1
    buffer_load_dwordx4 v[172:175], v4, s[44:47], s68 offen sc1
    s_add_u32 s65, s82, 2
    s_sub_u32 s67, s65, s64
    s_cmp_ge_u32 s65, s64
    s_cselect_b32 s65, s67, s65
    s_mul_i32 s67, s65, 5120
    s_add_u32 s67, s67, s81
    s_add_u32 s68, s67, 4096
    buffer_load_dwordx4 v[176:179], v4, s[44:47], s67 offen offset:0 sc1
    buffer_load_dwordx4 v[180:183], v4, s[44:47], s67 offen offset:1024 sc1
    buffer_load_dwordx4 v[184:187], v4, s[44:47], s67 offen offset:2048 sc1
    buffer_load_dwordx4 v[188:191], v4, s[44:47], s67 offen offset:3072 sc1
    buffer_load_dwordx4 v[192:195], v4, s[44:47], s68 offen sc1
    s_add_u32 s65, s82, 3
    s_sub_u32 s67, s65, s64
    s_cmp_ge_u32 s65, s64
    s_cselect_b32 s65, s67, s65
    s_mul_i32 s67, s65, 5120
    s_add_u32 s67, s67, s81
    s_add_u32 s68, s67, 4096
    buffer_load_dwordx4 v[196:199], v4, s[44:47], s67 offen offset:0 sc1
    buffer_load_dwordx4 v[200:203], v4, s[44:47], s67 offen offset:1024 sc1
    buffer_load_dwordx4 v[204:207], v4, s[44:47], s67 offen offset:2048 sc1
    buffer_load_dwordx4 v[208:211], v4, s[44:47], s67 offen offset:3072 sc1
    buffer_load_dwordx4 v[212:215], v4, s[44:47], s68 offen sc1
    s_cmp_eq_u32 s33, 1
    s_cbranch_scc1 L_attn
    s_branch L_bar3
L_helper:
    s_getpc_b64 s[56:57]
L_pc:
    s_sub_u32 s56, s56, L_pc-gated_mix__sliding_local_dilated__dense_activation_squared_relu__prompt_kernel
    s_subb_u32 s57, s57, 0
    s_lshr_b32 s58, s2, 3
    s_mul_i32 s58, s58, 12
    v_add_u32 v4, s58, v1
    v_lshlrev_b32 v2, 7, v4
    v_mov_b32 v3, s57
    v_add_co_u32 v2, vcc, s56, v2
    s_nop 1
    v_addc_co_u32 v3, vcc, 0, v3, vcc
    v_cmp_gt_u32 vcc, (L_end-gated_mix__sliding_local_dilated__dense_activation_squared_relu__prompt_kernel)/128, v4
    s_mov_b64 exec, 4095
    s_nop 2
    s_and_b64 exec, exec, vcc
    s_cbranch_execz L_ct_31
    global_load_dword v8, v[2:3], off
L_ct_31:
    s_mov_b64 exec, -1
    s_and_b32 s100, s2, 1
    s_bfe_u32 s101, s2, 0x20001
    s_lshr_b32 s85, s2, 3
    s_cmp_lt_u32 s85, 18
    s_cselect_b32 s33, 1, 0
    s_cbranch_scc0 L_role_bh
    s_mul_i32 s34, s100, 9
    s_lshr_b32 s58, s85, 1
    s_add_u32 s34, s34, s58
    s_lshl_b32 s35, s101, 1
    s_and_b32 s58, s85, 1
    s_add_u32 s35, s35, s58
    s_branch L_role_doneh
L_role_bh:
    s_mul_i32 s58, s101, 14
    s_add_u32 s58, s58, s85
    s_sub_u32 s58, s58, 18
    s_lshr_b32 s35, s58, 3
    s_and_b32 s58, s58, 7
    s_lshl_b32 s34, s100, 3
    s_add_u32 s34, s34, s58
L_role_doneh:
    s_mul_i32 s58, s100, 9
    s_lshl_b32 s59, s100, 3
    s_cmp_eq_u32 s33, 1
    s_cselect_b32 s58, s58, s59
    s_sub_u32 s3, s34, s58
    s_and_b32 s58, s35, 1
    s_mul_i32 s58, s58, 5
    s_add_u32 s3, s3, s58
    s_cmp_eq_u32 s33, 1
    s_cselect_b32 s58, 0, 2
    s_add_u32 s3, s3, s58
    s_mul_i32 s58, s3, 205
    s_lshr_b32 s58, s58, 11
    s_mul_i32 s58, s58, 10
    s_sub_u32 s3, s3, s58
    s_and_b32 s56, s2, 7
    s_lshr_b32 s57, s2, 3
    s_lshl_b32 s78, s56, 2
    s_lshr_b32 s58, s57, 3
    s_add_u32 s78, s78, s58
    s_and_b32 s79, s57, 7
    s_and_b32 s83, s35, 1
    s_mul_i32 s76, s34, 114
    s_sub_u32 s76, s76, 14
    s_cmp_eq_u32 s33, 1
    s_mov_b32 s77, 3456
    s_cselect_b32 s77, 3840, s77
    s_lshl_b32 s58, s34, 3
    s_add_u32 s58, s58, s35
    s_mul_i32 s59, s34, 7
    s_add_u32 s59, s59, s35
    s_add_u32 s59, s59, 144
    s_cmp_eq_u32 s33, 1
    s_cselect_b32 s84, s58, s59
    s_waitcnt lgkmcnt(0)
    s_mov_b32 s36, s8
    s_and_b32 s37, s9, 0xffff
    s_mov_b32 s38, 2621440
    s_mov_b32 s39, 0x20000
    s_cmp_eq_u32 s33, 1
    s_cselect_b32 s40, s10, s16
    s_cselect_b32 s56, s11, s17
    s_mov_b32 s42, 2211840
    s_cselect_b32 s42, 2457600, s42
    s_and_b32 s41, s56, 0xffff
    s_mov_b32 s43, 0x20000
    s_mov_b32 s44, s30
    s_and_b32 s45, s31, 0xffff
    s_mov_b32 s46, 14680064
    s_mov_b32 s47, 0x20000
    s_mov_b32 s96, s28
    s_and_b32 s97, s29, 0xffff
    s_mov_b32 s98, 256
    s_mov_b32 s99, 0x20000
    s_mov_b32 s48, s24
    s_and_b32 s49, s25, 0xffff
    s_mov_b32 s50, 1280
    s_mov_b32 s51, 0x20000
    v_lshlrev_b32 v2, 4, v1
    s_mov_b32 m0, 131072
    s_movk_i32 s56, 0
    buffer_load_dwordx4 v2, s[48:51], s56 offen lds
    s_mov_b32 m0, 132096
    s_movk_i32 s56, 1024
    buffer_load_dwordx4 v2, s[48:51], s56 offen lds
    s_cmp_lt_u32 s32, 2
    s_cbranch_scc1 L_p3o_32
    s_add_u32 s56, s32, 2
    s_sub_u32 s57, s32, 4
    s_cmp_ge_u32 s32, 4
    s_cselect_b32 s56, s57, s56
    s_mul_i32 s58, s56, 9
    s_mul_i32 s80, s78, 54
    s_add_u32 s80, s80, s58
    s_lshl_b32 s80, s80, 12
    s_add_u32 s59, s58, 20
    s_mov_b32 s64, 9
    s_mov_b32 s62, 2147483648
    s_branch L_p3d_33
L_p3o_32:
    s_mul_i32 s59, s32, 10
    s_mul_i32 s80, s78, 20
    s_add_u32 s80, s80, s59
    s_lshl_b32 s80, s80, 12
    s_add_u32 s80, s80, 7340032
    s_mov_b32 s64, 10
    s_mov_b32 s62, 0
L_p3d_33:
    s_mul_i32 s81, s79, 74
    s_add_u32 s81, s81, s59
    s_mul_i32 s81, s81, 5120
    s_add_u32 s81, s81, 10485760
    s_mov_b32 s82, s79
    s_sub_u32 s60, s82, s64
    s_cmp_ge_u32 s82, s64
    s_cselect_b32 s82, s60, s82
    v_lshrrev_b32 v6, 1, v1
    v_add_u32 v6, s59, v6
    v_mul_u32_u24 v6, 10, v6
    s_mul_i32 s60, s79, 5
    s_lshr_b32 s60, s60, 2
    v_and_b32 v7, 1, v1
    v_add_u32 v6, v6, v7
    v_add_u32 v6, s60, v6
    v_mul_u32_u24 v7, 16384, v6
    v_lshrrev_b32 v7, 16, v7
    v_cmp_gt_u32 vcc, 448, v6
    v_subrev_u32 v6, 448, v6
    v_and_b32 v6, 0x3ff, v6
    v_mul_u32_u24 v6, 21846, v6
    v_lshrrev_b32 v6, 16, v6
    v_add_u32 v6, 112, v6
    v_cndmask_b32 v6, v6, v7, vcc
    v_lshlrev_b32 v6, 6, v6
    s_lshl_b32 s60, s64, 1
    v_cmp_gt_u32 vcc, s60, v1
    v_mov_b32 v7, 2147483648
    s_nop 0
    v_cndmask_b32 v232, v7, v6, vcc
    s_cmp_eq_u32 s33, 1
    s_cbranch_scc0 L_aa_34
    s_and_b32 s56, s32, 3
    s_lshr_b32 s57, s32, 2
    s_mul_i32 s58, s57, 31232
    s_mul_i32 s59, s56, 40
    s_add_u32 s58, s58, s59
    s_add_u32 s58, s58, 28864
    v_mul_u32_u24 v240, 488, v1
    v_add_u32 v240, s58, v240
    v_and_b32 v60, 48, v1
    v_and_b32 v61, 3, v1
    v_lshl_add_u32 v60, v61, 2, v60
    v_bfe_u32 v61, v1, 2, 2
    v_add_u32 v60, v60, v61
    v_mul_u32_u24 v241, 488, v60
    v_add_u32 v241, s58, v241
    s_mul_i32 s58, s57, 11264
    s_add_u32 s58, s58, s59
    s_add_u32 s58, s58, 133120
    v_mul_u32_u24 v242, 176, v1
    v_add_u32 v242, s58, v242
    s_add_u32 s56, s32, 0
    s_lshr_b32 s57, s56, 1
    s_and_b32 s56, s56, 1
    s_lshl_b32 s58, s56, 6
    v_add_u32 v60, s58, v1
    v_add_u32 v61, 14, v60
    v_and_b32 v62, 1, v61
    v_lshrrev_b32 v63, 1, v61
    v_lshl_add_u32 v62, v62, 6, v63
    v_min_u32 v62, 127, v62
    v_mul_u32_u24 v62, 176, v62
    s_lshl_b32 s59, s57, 4
    s_add_u32 s59, s59, 133120
    v_add_u32 v243, s59, v62
    s_add_u32 s59, s76, 14
    v_add_u32 v63, s59, v60
    s_mul_i32 s60, s35, 10
    s_add_u32 s60, s60, s57
    s_lshr_b32 s61, s60, 2
    s_and_b32 s60, s60, 3
    s_lshl_b32 s61, s61, 12
    s_lshl_b32 s60, s60, 8
    s_add_u32 s61, s61, s60
    s_add_u32 s71, s61, 7340032
    v_lshrrev_b32 v64, 6, v63
    v_mul_u32_u24 v64, 81920, v64
    v_bfe_u32 v65, v63, 4, 2
    v_lshl_add_u32 v64, v65, 10, v64
    v_and_b32 v65, 15, v63
    v_lshl_add_u32 v64, v65, 4, v64
    v_cmp_gt_u32 vcc, 114, v60
    s_nop 3
    s_mov_b64 s[88:89], vcc
    v_cmp_gt_u32 vcc, 2048, v63
    s_nop 3
    s_and_b64 vcc, vcc, s[88:89]
    v_mov_b32 v65, 2147483648
    s_nop 1
    v_cndmask_b32 v244, v65, v64, vcc
    s_add_u32 s56, s32, 8
    s_lshr_b32 s57, s56, 1
    s_and_b32 s56, s56, 1
    s_lshl_b32 s58, s56, 6
    v_add_u32 v60, s58, v1
    v_add_u32 v61, 14, v60
    v_and_b32 v62, 1, v61
    v_lshrrev_b32 v63, 1, v61
    v_lshl_add_u32 v62, v62, 6, v63
    v_min_u32 v62, 127, v62
    v_mul_u32_u24 v62, 176, v62
    s_lshl_b32 s59, s57, 4
    s_add_u32 s59, s59, 133120
    v_add_u32 v245, s59, v62
    s_add_u32 s59, s76, 14
    v_add_u32 v63, s59, v60
    s_mul_i32 s60, s35, 10
    s_add_u32 s60, s60, s57
    s_lshr_b32 s61, s60, 2
    s_and_b32 s60, s60, 3
    s_lshl_b32 s61, s61, 12
    s_lshl_b32 s60, s60, 8
    s_add_u32 s61, s61, s60
    s_add_u32 s72, s61, 7340032
    v_lshrrev_b32 v64, 6, v63
    v_mul_u32_u24 v64, 81920, v64
    v_bfe_u32 v65, v63, 4, 2
    v_lshl_add_u32 v64, v65, 10, v64
    v_and_b32 v65, 15, v63
    v_lshl_add_u32 v64, v65, 4, v64
    v_cmp_gt_u32 vcc, 114, v60
    s_nop 3
    s_mov_b64 s[88:89], vcc
    v_cmp_gt_u32 vcc, 2048, v63
    s_nop 3
    s_and_b64 vcc, vcc, s[88:89]
    v_mov_b32 v65, 2147483648
    s_nop 1
    v_cndmask_b32 v246, v65, v64, vcc
    s_add_u32 s56, s32, 16
    s_lshr_b32 s57, s56, 1
    s_and_b32 s56, s56, 1
    s_lshl_b32 s58, s56, 6
    v_add_u32 v60, s58, v1
    v_add_u32 v61, 14, v60
    v_and_b32 v62, 1, v61
    v_lshrrev_b32 v63, 1, v61
    v_lshl_add_u32 v62, v62, 6, v63
    v_min_u32 v62, 127, v62
    v_mul_u32_u24 v62, 176, v62
    s_lshl_b32 s59, s57, 4
    s_add_u32 s59, s59, 133120
    v_add_u32 v247, s59, v62
    s_add_u32 s59, s76, 14
    v_add_u32 v63, s59, v60
    s_mul_i32 s60, s35, 10
    s_add_u32 s60, s60, s57
    s_lshr_b32 s61, s60, 2
    s_and_b32 s60, s60, 3
    s_lshl_b32 s61, s61, 12
    s_lshl_b32 s60, s60, 8
    s_add_u32 s61, s61, s60
    s_add_u32 s73, s61, 7340032
    v_lshrrev_b32 v64, 6, v63
    v_mul_u32_u24 v64, 81920, v64
    v_bfe_u32 v65, v63, 4, 2
    v_lshl_add_u32 v64, v65, 10, v64
    v_and_b32 v65, 15, v63
    v_lshl_add_u32 v64, v65, 4, v64
    v_cmp_gt_u32 vcc, 114, v60
    s_nop 3
    s_mov_b64 s[88:89], vcc
    v_cmp_gt_u32 vcc, 2048, v63
    s_nop 3
    s_and_b64 vcc, vcc, s[88:89]
    v_mov_b32 v65, 2147483648
    s_nop 1
    v_cndmask_b32 v248, v65, v64, vcc
L_aa_34:
    s_mov_b32 s88, s10
    s_and_b32 s89, s11, 0xffff
    s_mov_b32 s90, 2457600
    s_mov_b32 s91, 0x20000
    s_mov_b32 s92, s16
    s_and_b32 s93, s17, 0xffff
    s_mov_b32 s94, 2211840
    s_mov_b32 s95, 0x20000
    s_mul_i32 s56, s100, 1012
    s_mul_i32 s57, s85, 33
    s_add_u32 s56, s56, s57
    v_add_u32 v3, s56, v1
    v_mul_u32_u24 v4, 1280, v3
    v_mov_b32 v5, 2147483648
    v_cmp_gt_u32 vcc, 2048, v3
    s_nop 1
    v_cndmask_b32 v4, v5, v4, vcc
    v_cmp_gt_u32 vcc, 33, v1
    s_nop 1
    v_cndmask_b32 v4, v5, v4, vcc
    s_mov_b32 s65, 0
    s_mov_b32 s66, 0
    s_mov_b32 s67, 0
    v_mul_u32_u24 v6, 43, v1
    v_lshrrev_b32 v6, 7, v6
    v_mul_u32_u24 v7, 3, v6
    v_sub_u32 v7, v1, v7
    v_mul_u32_u24 v6, 1280, v6
    v_lshl_add_u32 v6, v7, 7, v6
    s_mul_i32 s56, s101, 320
    s_and_b32 s56, s56, 0xffffff80
    s_mul_i32 s57, s85, 3840
    s_add_u32 s56, s56, s57
    v_add_u32 v6, s56, v6
    v_cmp_gt_u32 vcc, 9, v1
    s_nop 1
    v_cndmask_b32 v6, v5, v6, vcc
    s_mul_i32 s56, s101, 14
    s_add_u32 s57, s56, 13
    s_lshr_b32 s56, s56, 3
    s_lshr_b32 s57, s57, 3
    s_add_u32 s57, s57, 1
    s_lshl_b32 s56, s56, 9
    s_lshl_b32 s57, s57, 9
    s_min_u32 s57, s57, 3456
    v_lshlrev_b32 v7, 7, v1
    v_add_u32 v7, s56, v7
    v_cmp_gt_u32 vcc, s57, v7
    s_mul_i32 s58, s85, 3456
    v_add_u32 v7, s58, v7
    v_cndmask_b32 v7, v5, v7, vcc
    v_lshrrev_b32 v12, 5, v1
    v_lshlrev_b32 v12, 4, v12
    v_bfe_u32 v13, v1, 3, 2
    v_lshl_add_u32 v12, v13, 1, v12
    v_bfe_u32 v13, v1, 1, 1
    v_add_u32 v12, v12, v13
    v_bfe_u32 v13, v1, 2, 1
    v_lshl_add_u32 v12, v13, 3, v12
    v_lshlrev_b32 v13, 1, v12
    v_add_u32 v13, 131072, v13
    v_add_u32 v9, 1280, v13
    s_lshl_b32 s56, s3, 7
    v_add_u32 v13, s56, v13
    v_lshrrev_b32 v14, 3, v12
    v_and_b32 v14, 1, v14
    v_xor_b32 v14, 1, v14
    v_lshlrev_b32 v14, 5, v14
    v_lshl_add_u32 v14, v12, 6, v14
    v_and_b32 v15, 1, v1
    v_lshl_add_u32 v14, v15, 4, v14
    v_add_u32 v24, 79872, v14
    v_add_u32 v25, 96256, v14
    v_add_u32 v26, 112640, v14
    v_add_u32 v27, 129024, v14
    s_cmp_eq_u32 s35, 0
    s_cselect_b32 s74, 1, 2
    s_cmp_eq_u32 s33, 1
    s_cselect_b32 s74, s74, 0
    s_sub_u32 s75, s84, 144
    s_mul_i32 s15, s75, 4
    s_mov_b32 s77, 4
    s_mul_i32 s56, s34, 7
    s_add_u32 s56, s56, s35
    s_sub_u32 s56, s56, 1
    s_mul_i32 s57, s56, 3
    s_add_u32 s57, s57, 448
    s_add_u32 s56, s56, 112
    s_cmp_eq_u32 s33, 1
    s_cselect_b32 s75, s56, s75
    s_cselect_b32 s15, s57, s15
    s_cselect_b32 s77, 3, s77
    s_cmp_eq_u32 s74, 1
    s_cselect_b32 s77, 0, s77
    s_mov_b32 s88, s12
    s_and_b32 s89, s13, 0xffff
    s_mov_b32 s90, 819200
    s_mov_b32 s91, 0x20000
    s_mov_b32 s92, s20
    s_and_b32 s93, s21, 0xffff
    s_mov_b32 s94, 2211840
    s_mov_b32 s95, 0x20000
    v_mov_b32 v44, 2147483648
    v_mov_b32 v140, 131072
    v_mov_b32 v141, 131072
    v_mov_b32 v142, 2147483648
    s_mov_b32 s8, 0
    v_mov_b32 v45, 2147483648
    v_mov_b32 v143, 131072
    v_mov_b32 v144, 131072
    v_mov_b32 v145, 2147483648
    s_mov_b32 s9, 0
    v_mov_b32 v46, 2147483648
    v_mov_b32 v146, 131072
    v_mov_b32 v147, 131072
    v_mov_b32 v148, 2147483648
    s_mov_b32 s10, 0
    v_mov_b32 v47, 2147483648
    v_mov_b32 v149, 131072
    v_mov_b32 v150, 131072
    v_mov_b32 v151, 2147483648
    s_mov_b32 s11, 0
    v_mov_b32 v170, 0
    s_cmp_eq_u32 s77, 0
    s_cbranch_scc1 L_rpsetup_35
    v_lshrrev_b32 v10, 3, v1
    v_mul_u32_u24 v10, 1280, v10
    v_and_b32 v11, 7, v1
    v_lshl_add_u32 v10, v11, 4, v10
    v_lshrrev_b32 v16, 4, v1
    v_bfe_u32 v17, v1, 2, 2
    v_and_b32 v18, 3, v1
    v_lshlrev_b32 v21, 4, v1
    s_add_u32 s59, s15, 0
    s_mul_i32 s56, s59, 205
    s_lshr_b32 s56, s56, 11
    s_mul_i32 s60, s56, 10
    s_sub_u32 s57, s59, s60
    s_cmp_lt_u32 s59, 740
    s_cselect_b32 s58, 0, 2147483648
    s_cmp_gt_u32 s77, 0
    s_cselect_b32 s58, s58, 2147483648
    s_cmp_lt_u32 s56, 20
    s_cselect_b32 s60, 0, 20
    s_cselect_b32 s61, 3, 2
    s_mov_b32 s62, 2048
    s_cselect_b32 s62, 512, s62
    s_cselect_b32 s70, 1, 0
    s_sub_u32 s60, s56, s60
    s_mul_i32 s60, s60, 40960
    s_lshl_b32 s70, s70, 31
    s_or_b32 s8, s60, s70
    s_lshl_b32 s60, s57, 7
    s_or_b32 s60, s60, s58
    v_add_u32 v44, s60, v10
    v_lshlrev_b32 v19, s61, v16
    v_add_u32 v19, v19, v17
    v_lshlrev_b32 v19, 7, v19
    v_lshl_add_u32 v19, v18, 3, v19
    v_add_u32 v140, 131072, v19
    v_add_u32 v141, s62, v140
    v_or_b32 v142, s58, v21
    s_lshl_b32 s59, s57, 2
    s_mul_i32 s60, s59, 52
    s_lshr_b32 s60, s60, 8
    s_mul_i32 s60, s60, 365
    s_add_u32 s60, s60, s59
    s_mul_i32 s61, s56, 5
    s_add_u32 s60, s60, s61
    s_lshl_b32 s60, s60, 10
    s_add_u32 s60, s60, 10485760
    s_and_b32 s60, s60, 0x00ffffff
    v_writelane_b32 v170, s60, 0
    s_add_u32 s59, s59, 1
    s_mul_i32 s60, s59, 52
    s_lshr_b32 s60, s60, 8
    s_mul_i32 s60, s60, 365
    s_add_u32 s60, s60, s59
    s_mul_i32 s61, s56, 5
    s_add_u32 s60, s60, s61
    s_lshl_b32 s60, s60, 10
    s_add_u32 s60, s60, 10485760
    s_and_b32 s60, s60, 0x00ffffff
    v_writelane_b32 v170, s60, 1
    s_add_u32 s59, s59, 1
    s_mul_i32 s60, s59, 52
    s_lshr_b32 s60, s60, 8
    s_mul_i32 s60, s60, 365
    s_add_u32 s60, s60, s59
    s_mul_i32 s61, s56, 5
    s_add_u32 s60, s60, s61
    s_lshl_b32 s60, s60, 10
    s_add_u32 s60, s60, 10485760
    s_and_b32 s60, s60, 0x00ffffff
    v_writelane_b32 v170, s60, 2
    s_add_u32 s59, s59, 1
    s_mul_i32 s60, s59, 52
    s_lshr_b32 s60, s60, 8
    s_mul_i32 s60, s60, 365
    s_add_u32 s60, s60, s59
    s_mul_i32 s61, s56, 5
    s_add_u32 s60, s60, s61
    s_lshl_b32 s60, s60, 10
    s_add_u32 s60, s60, 10485760
    s_and_b32 s60, s60, 0x00ffffff
    v_writelane_b32 v170, s60, 3
    s_add_u32 s59, s59, 1
    s_add_u32 s59, s15, 1
    s_mul_i32 s56, s59, 205
    s_lshr_b32 s56, s56, 11
    s_mul_i32 s60, s56, 10
    s_sub_u32 s57, s59, s60
    s_cmp_lt_u32 s59, 740
    s_cselect_b32 s58, 0, 2147483648
    s_cmp_gt_u32 s77, 1
    s_cselect_b32 s58, s58, 2147483648
    s_cmp_lt_u32 s56, 20
    s_cselect_b32 s60, 0, 20
    s_cselect_b32 s61, 3, 2
    s_mov_b32 s62, 2048
    s_cselect_b32 s62, 512, s62
    s_cselect_b32 s70, 1, 0
    s_sub_u32 s60, s56, s60
    s_mul_i32 s60, s60, 40960
    s_lshl_b32 s70, s70, 31
    s_or_b32 s9, s60, s70
    s_lshl_b32 s60, s57, 7
    s_or_b32 s60, s60, s58
    v_add_u32 v45, s60, v10
    v_lshlrev_b32 v19, s61, v16
    v_add_u32 v19, v19, v17
    v_lshlrev_b32 v19, 7, v19
    v_lshl_add_u32 v19, v18, 3, v19
    v_add_u32 v143, 135168, v19
    v_add_u32 v144, s62, v143
    v_or_b32 v145, s58, v21
    s_lshl_b32 s59, s57, 2
    s_mul_i32 s60, s59, 52
    s_lshr_b32 s60, s60, 8
    s_mul_i32 s60, s60, 365
    s_add_u32 s60, s60, s59
    s_mul_i32 s61, s56, 5
    s_add_u32 s60, s60, s61
    s_lshl_b32 s60, s60, 10
    s_add_u32 s60, s60, 10485760
    s_and_b32 s60, s60, 0x00ffffff
    v_writelane_b32 v170, s60, 4
    s_add_u32 s59, s59, 1
    s_mul_i32 s60, s59, 52
    s_lshr_b32 s60, s60, 8
    s_mul_i32 s60, s60, 365
    s_add_u32 s60, s60, s59
    s_mul_i32 s61, s56, 5
    s_add_u32 s60, s60, s61
    s_lshl_b32 s60, s60, 10
    s_add_u32 s60, s60, 10485760
    s_and_b32 s60, s60, 0x00ffffff
    v_writelane_b32 v170, s60, 5
    s_add_u32 s59, s59, 1
    s_mul_i32 s60, s59, 52
    s_lshr_b32 s60, s60, 8
    s_mul_i32 s60, s60, 365
    s_add_u32 s60, s60, s59
    s_mul_i32 s61, s56, 5
    s_add_u32 s60, s60, s61
    s_lshl_b32 s60, s60, 10
    s_add_u32 s60, s60, 10485760
    s_and_b32 s60, s60, 0x00ffffff
    v_writelane_b32 v170, s60, 6
    s_add_u32 s59, s59, 1
    s_mul_i32 s60, s59, 52
    s_lshr_b32 s60, s60, 8
    s_mul_i32 s60, s60, 365
    s_add_u32 s60, s60, s59
    s_mul_i32 s61, s56, 5
    s_add_u32 s60, s60, s61
    s_lshl_b32 s60, s60, 10
    s_add_u32 s60, s60, 10485760
    s_and_b32 s60, s60, 0x00ffffff
    v_writelane_b32 v170, s60, 7
    s_add_u32 s59, s59, 1
    s_add_u32 s59, s15, 2
    s_mul_i32 s56, s59, 205
    s_lshr_b32 s56, s56, 11
    s_mul_i32 s60, s56, 10
    s_sub_u32 s57, s59, s60
    s_cmp_lt_u32 s59, 740
    s_cselect_b32 s58, 0, 2147483648
    s_cmp_gt_u32 s77, 2
    s_cselect_b32 s58, s58, 2147483648
    s_cmp_lt_u32 s56, 20
    s_cselect_b32 s60, 0, 20
    s_cselect_b32 s61, 3, 2
    s_mov_b32 s62, 2048
    s_cselect_b32 s62, 512, s62
    s_cselect_b32 s70, 1, 0
    s_sub_u32 s60, s56, s60
    s_mul_i32 s60, s60, 40960
    s_lshl_b32 s70, s70, 31
    s_or_b32 s10, s60, s70
    s_lshl_b32 s60, s57, 7
    s_or_b32 s60, s60, s58
    v_add_u32 v46, s60, v10
    v_lshlrev_b32 v19, s61, v16
    v_add_u32 v19, v19, v17
    v_lshlrev_b32 v19, 7, v19
    v_lshl_add_u32 v19, v18, 3, v19
    v_add_u32 v146, 139264, v19
    v_add_u32 v147, s62, v146
    v_or_b32 v148, s58, v21
    s_lshl_b32 s59, s57, 2
    s_mul_i32 s60, s59, 52
    s_lshr_b32 s60, s60, 8
    s_mul_i32 s60, s60, 365
    s_add_u32 s60, s60, s59
    s_mul_i32 s61, s56, 5
    s_add_u32 s60, s60, s61
    s_lshl_b32 s60, s60, 10
    s_add_u32 s60, s60, 10485760
    s_and_b32 s60, s60, 0x00ffffff
    v_writelane_b32 v170, s60, 8
    s_add_u32 s59, s59, 1
    s_mul_i32 s60, s59, 52
    s_lshr_b32 s60, s60, 8
    s_mul_i32 s60, s60, 365
    s_add_u32 s60, s60, s59
    s_mul_i32 s61, s56, 5
    s_add_u32 s60, s60, s61
    s_lshl_b32 s60, s60, 10
    s_add_u32 s60, s60, 10485760
    s_and_b32 s60, s60, 0x00ffffff
    v_writelane_b32 v170, s60, 9
    s_add_u32 s59, s59, 1
    s_mul_i32 s60, s59, 52
    s_lshr_b32 s60, s60, 8
    s_mul_i32 s60, s60, 365
    s_add_u32 s60, s60, s59
    s_mul_i32 s61, s56, 5
    s_add_u32 s60, s60, s61
    s_lshl_b32 s60, s60, 10
    s_add_u32 s60, s60, 10485760
    s_and_b32 s60, s60, 0x00ffffff
    v_writelane_b32 v170, s60, 10
    s_add_u32 s59, s59, 1
    s_mul_i32 s60, s59, 52
    s_lshr_b32 s60, s60, 8
    s_mul_i32 s60, s60, 365
    s_add_u32 s60, s60, s59
    s_mul_i32 s61, s56, 5
    s_add_u32 s60, s60, s61
    s_lshl_b32 s60, s60, 10
    s_add_u32 s60, s60, 10485760
    s_and_b32 s60, s60, 0x00ffffff
    v_writelane_b32 v170, s60, 11
    s_add_u32 s59, s59, 1
    s_add_u32 s59, s15, 3
    s_mul_i32 s56, s59, 205
    s_lshr_b32 s56, s56, 11
    s_mul_i32 s60, s56, 10
    s_sub_u32 s57, s59, s60
    s_cmp_lt_u32 s59, 740
    s_cselect_b32 s58, 0, 2147483648
    s_cmp_gt_u32 s77, 3
    s_cselect_b32 s58, s58, 2147483648
    s_cmp_lt_u32 s56, 20
    s_cselect_b32 s60, 0, 20
    s_cselect_b32 s61, 3, 2
    s_mov_b32 s62, 2048
    s_cselect_b32 s62, 512, s62
    s_cselect_b32 s70, 1, 0
    s_sub_u32 s60, s56, s60
    s_mul_i32 s60, s60, 40960
    s_lshl_b32 s70, s70, 31
    s_or_b32 s11, s60, s70
    s_lshl_b32 s60, s57, 7
    s_or_b32 s60, s60, s58
    v_add_u32 v47, s60, v10
    v_lshlrev_b32 v19, s61, v16
    v_add_u32 v19, v19, v17
    v_lshlrev_b32 v19, 7, v19
    v_lshl_add_u32 v19, v18, 3, v19
    v_add_u32 v149, 143360, v19
    v_add_u32 v150, s62, v149
    v_or_b32 v151, s58, v21
    s_lshl_b32 s59, s57, 2
    s_mul_i32 s60, s59, 52
    s_lshr_b32 s60, s60, 8
    s_mul_i32 s60, s60, 365
    s_add_u32 s60, s60, s59
    s_mul_i32 s61, s56, 5
    s_add_u32 s60, s60, s61
    s_lshl_b32 s60, s60, 10
    s_add_u32 s60, s60, 10485760
    s_and_b32 s60, s60, 0x00ffffff
    v_writelane_b32 v170, s60, 12
    s_add_u32 s59, s59, 1
    s_mul_i32 s60, s59, 52
    s_lshr_b32 s60, s60, 8
    s_mul_i32 s60, s60, 365
    s_add_u32 s60, s60, s59
    s_mul_i32 s61, s56, 5
    s_add_u32 s60, s60, s61
    s_lshl_b32 s60, s60, 10
    s_add_u32 s60, s60, 10485760
    s_and_b32 s60, s60, 0x00ffffff
    v_writelane_b32 v170, s60, 13
    s_add_u32 s59, s59, 1
    s_mul_i32 s60, s59, 52
    s_lshr_b32 s60, s60, 8
    s_mul_i32 s60, s60, 365
    s_add_u32 s60, s60, s59
    s_mul_i32 s61, s56, 5
    s_add_u32 s60, s60, s61
    s_lshl_b32 s60, s60, 10
    s_add_u32 s60, s60, 10485760
    s_and_b32 s60, s60, 0x00ffffff
    v_writelane_b32 v170, s60, 14
    s_add_u32 s59, s59, 1
    s_mul_i32 s60, s59, 52
    s_lshr_b32 s60, s60, 8
    s_mul_i32 s60, s60, 365
    s_add_u32 s60, s60, s59
    s_mul_i32 s61, s56, 5
    s_add_u32 s60, s60, s61
    s_lshl_b32 s60, s60, 10
    s_add_u32 s60, s60, 10485760
    s_and_b32 s60, s60, 0x00ffffff
    v_writelane_b32 v170, s60, 15
    s_add_u32 s59, s59, 1
L_rpsetup_35:
    s_waitcnt vmcnt(0)
    s_cmp_eq_u32 s74, 1
    s_cbranch_scc0 L_gz_37
    ds_read_u16 v100, v13
    v_add_u32 v13, 64, v13
    v_subrev_u32 v23, 1280, v13
    v_cmp_le_u32 vcc, v9, v13
    s_nop 1
    v_cndmask_b32 v13, v13, v23, vcc
    ds_read_u16 v101, v13
    v_add_u32 v13, 64, v13
    v_subrev_u32 v23, 1280, v13
    v_cmp_le_u32 vcc, v9, v13
    s_nop 1
    v_cndmask_b32 v13, v13, v23, vcc
    ds_read_u16 v102, v13
    v_add_u32 v13, 64, v13
    v_subrev_u32 v23, 1280, v13
    v_cmp_le_u32 vcc, v9, v13
    s_nop 1
    v_cndmask_b32 v13, v13, v23, vcc
    ds_read_u16 v103, v13
    v_add_u32 v13, 64, v13
    v_subrev_u32 v23, 1280, v13
    v_cmp_le_u32 vcc, v9, v13
    s_nop 1
    v_cndmask_b32 v13, v13, v23, vcc
    ds_read_u16 v104, v13
    v_add_u32 v13, 64, v13
    v_subrev_u32 v23, 1280, v13
    v_cmp_le_u32 vcc, v9, v13
    s_nop 1
    v_cndmask_b32 v13, v13, v23, vcc
    ds_read_u16 v105, v13
    v_add_u32 v13, 64, v13
    v_subrev_u32 v23, 1280, v13
    v_cmp_le_u32 vcc, v9, v13
    s_nop 1
    v_cndmask_b32 v13, v13, v23, vcc
    ds_read_u16 v106, v13
    v_add_u32 v13, 64, v13
    v_subrev_u32 v23, 1280, v13
    v_cmp_le_u32 vcc, v9, v13
    s_nop 1
    v_cndmask_b32 v13, v13, v23, vcc
    ds_read_u16 v107, v13
    v_add_u32 v13, 64, v13
    v_subrev_u32 v23, 1280, v13
    v_cmp_le_u32 vcc, v9, v13
    s_nop 1
    v_cndmask_b32 v13, v13, v23, vcc
    ds_read_u16 v108, v13
    v_add_u32 v13, 64, v13
    v_subrev_u32 v23, 1280, v13
    v_cmp_le_u32 vcc, v9, v13
    s_nop 1
    v_cndmask_b32 v13, v13, v23, vcc
    ds_read_u16 v109, v13
    v_add_u32 v13, 64, v13
    v_subrev_u32 v23, 1280, v13
    v_cmp_le_u32 vcc, v9, v13
    s_nop 1
    v_cndmask_b32 v13, v13, v23, vcc
    ds_read_u16 v110, v13
    v_add_u32 v13, 64, v13
    v_subrev_u32 v23, 1280, v13
    v_cmp_le_u32 vcc, v9, v13
    s_nop 1
    v_cndmask_b32 v13, v13, v23, vcc
    ds_read_u16 v111, v13
    v_add_u32 v13, 64, v13
    v_subrev_u32 v23, 1280, v13
    v_cmp_le_u32 vcc, v9, v13
    s_nop 1
    v_cndmask_b32 v13, v13, v23, vcc
    ds_read_u16 v112, v13
    v_add_u32 v13, 64, v13
    v_subrev_u32 v23, 1280, v13
    v_cmp_le_u32 vcc, v9, v13
    s_nop 1
    v_cndmask_b32 v13, v13, v23, vcc
    ds_read_u16 v113, v13
    v_add_u32 v13, 64, v13
    v_subrev_u32 v23, 1280, v13
    v_cmp_le_u32 vcc, v9, v13
    s_nop 1
    v_cndmask_b32 v13, v13, v23, vcc
    ds_read_u16 v114, v13
    v_add_u32 v13, 64, v13
    v_subrev_u32 v23, 1280, v13
    v_cmp_le_u32 vcc, v9, v13
    s_nop 1
    v_cndmask_b32 v13, v13, v23, vcc
    ds_read_u16 v115, v13
    v_add_u32 v13, 64, v13
    v_subrev_u32 v23, 1280, v13
    v_cmp_le_u32 vcc, v9, v13
    s_nop 1
    v_cndmask_b32 v13, v13, v23, vcc
    ds_read_u16 v116, v13
    v_add_u32 v13, 64, v13
    v_subrev_u32 v23, 1280, v13
    v_cmp_le_u32 vcc, v9, v13
    s_nop 1
    v_cndmask_b32 v13, v13, v23, vcc
    ds_read_u16 v117, v13
    v_add_u32 v13, 64, v13
    v_subrev_u32 v23, 1280, v13
    v_cmp_le_u32 vcc, v9, v13
    s_nop 1
    v_cndmask_b32 v13, v13, v23, vcc
    ds_read_u16 v118, v13
    v_add_u32 v13, 64, v13
    v_subrev_u32 v23, 1280, v13
    v_cmp_le_u32 vcc, v9, v13
    s_nop 1
    v_cndmask_b32 v13, v13, v23, vcc
    ds_read_u16 v119, v13
    v_add_u32 v13, 64, v13
    v_subrev_u32 v23, 1280, v13
    v_cmp_le_u32 vcc, v9, v13
    s_nop 1
    v_cndmask_b32 v13, v13, v23, vcc
    s_waitcnt lgkmcnt(0)
    v_lshl_or_b32 v100, v100, 16, v100
    v_lshl_or_b32 v101, v101, 16, v101
    v_lshl_or_b32 v102, v102, 16, v102
    v_lshl_or_b32 v103, v103, 16, v103
    v_lshl_or_b32 v104, v104, 16, v104
    v_lshl_or_b32 v105, v105, 16, v105
    v_lshl_or_b32 v106, v106, 16, v106
    v_lshl_or_b32 v107, v107, 16, v107
    v_lshl_or_b32 v108, v108, 16, v108
    v_lshl_or_b32 v109, v109, 16, v109
    v_lshl_or_b32 v110, v110, 16, v110
    v_lshl_or_b32 v111, v111, 16, v111
    v_lshl_or_b32 v112, v112, 16, v112
    v_lshl_or_b32 v113, v113, 16, v113
    v_lshl_or_b32 v114, v114, 16, v114
    v_lshl_or_b32 v115, v115, 16, v115
    v_lshl_or_b32 v116, v116, 16, v116
    v_lshl_or_b32 v117, v117, 16, v117
    v_lshl_or_b32 v118, v118, 16, v118
    v_lshl_or_b32 v119, v119, 16, v119
    s_branch L_gv_36
L_gz_37:
    s_cmp_eq_u32 s74, 2
    s_cbranch_scc0 L_gv_36
    v_mov_b32 v32, 0
    v_mov_b32 v33, 0
    v_mov_b32 v34, 0
    v_mov_b32 v35, 0
    ds_write_b128 v24, v[32:35]
    ds_write_b128 v25, v[32:35]
    ds_write_b128 v26, v[32:35]
    ds_write_b128 v27, v[32:35]
    s_waitcnt lgkmcnt(0)
L_gv_36:
    s_cmp_eq_u32 s74, 1
    s_cbranch_scc0 L_gw_38
    v_mov_b32 v32, v100
    v_mov_b32 v33, v100
    v_mov_b32 v34, v100
    v_mov_b32 v35, v100
    ds_write_b128 v24, v[32:35]
    v_mov_b32 v32, v101
    v_mov_b32 v33, v101
    v_mov_b32 v34, v101
    v_mov_b32 v35, v101
    ds_write_b128 v25, v[32:35]
    v_mov_b32 v32, v102
    v_mov_b32 v33, v102
    v_mov_b32 v34, v102
    v_mov_b32 v35, v102
    ds_write_b128 v26, v[32:35]
    s_waitcnt lgkmcnt(0)
L_gw_38:
    s_barrier
    s_barrier
    s_setprio 2
    s_cmp_eq_u32 s74, 1
    s_cbranch_scc0 L_gw_39
    v_mov_b32 v32, v103
    v_mov_b32 v33, v103
    v_mov_b32 v34, v103
    v_mov_b32 v35, v103
    ds_write_b128 v27, v[32:35]
    s_waitcnt lgkmcnt(0)
L_gw_39:
    s_barrier
    s_cmp_eq_u32 s74, 1
    s_cbranch_scc0 L_gw_40
    v_mov_b32 v32, v104
    v_mov_b32 v33, v104
    v_mov_b32 v34, v104
    v_mov_b32 v35, v104
    ds_write_b128 v24, v[32:35]
    s_waitcnt lgkmcnt(0)
L_gw_40:
    s_barrier
    s_cmp_eq_u32 s74, 1
    s_cbranch_scc0 L_gw_41
    v_mov_b32 v32, v105
    v_mov_b32 v33, v105
    v_mov_b32 v34, v105
    v_mov_b32 v35, v105
    ds_write_b128 v25, v[32:35]
    s_waitcnt lgkmcnt(0)
L_gw_41:
    s_cmp_eq_u32 s77, 0
    s_cbranch_scc1 L_bo_42
    s_and_b32 s60, s8, 0x7fffffff
    s_bitcmp1_b32 s8, 31
    s_cbranch_scc1 L_rpw_43
    s_mov_b32 m0, 131072
    s_nop 0
    buffer_load_dwordx4 v44, s[92:95], s60 offen  lds
    s_add_u32 s60, s60, 10240
    s_mov_b32 m0, 132096
    s_nop 0
    buffer_load_dwordx4 v44, s[92:95], s60 offen  lds
    s_add_u32 s60, s60, 10240
    s_mov_b32 m0, 133120
    s_nop 0
    buffer_load_dwordx4 v44, s[92:95], s60 offen  lds
    s_add_u32 s60, s60, 10240
    s_mov_b32 m0, 134144
    s_nop 0
    buffer_load_dwordx4 v44, s[92:95], s60 offen  lds
    s_branch L_rpd_44
L_rpw_43:
    s_mov_b32 m0, 131072
    s_nop 0
    buffer_load_dwordx4 v44, s[88:91], s60 offen  lds
    s_add_u32 s60, s60, 10240
    s_mov_b32 m0, 132096
    s_nop 0
    buffer_load_dwordx4 v44, s[88:91], s60 offen  lds
    s_add_u32 s60, s60, 10240
    s_mov_b32 m0, 133120
    s_nop 0
    buffer_load_dwordx4 v44, s[88:91], s60 offen  lds
    s_add_u32 s60, s60, 10240
    s_mov_b32 m0, 134144
    s_nop 0
    buffer_load_dwordx4 v44, s[88:91], s60 offen  lds
L_rpd_44:
    s_and_b32 s60, s9, 0x7fffffff
    s_bitcmp1_b32 s9, 31
    s_cbranch_scc1 L_rpw_45
    s_mov_b32 m0, 135168
    s_nop 0
    buffer_load_dwordx4 v45, s[92:95], s60 offen  lds
    s_add_u32 s60, s60, 10240
    s_mov_b32 m0, 136192
    s_nop 0
    buffer_load_dwordx4 v45, s[92:95], s60 offen  lds
    s_add_u32 s60, s60, 10240
    s_mov_b32 m0, 137216
    s_nop 0
    buffer_load_dwordx4 v45, s[92:95], s60 offen  lds
    s_add_u32 s60, s60, 10240
    s_mov_b32 m0, 138240
    s_nop 0
    buffer_load_dwordx4 v45, s[92:95], s60 offen  lds
    s_branch L_rpd_46
L_rpw_45:
    s_mov_b32 m0, 135168
    s_nop 0
    buffer_load_dwordx4 v45, s[88:91], s60 offen  lds
    s_add_u32 s60, s60, 10240
    s_mov_b32 m0, 136192
    s_nop 0
    buffer_load_dwordx4 v45, s[88:91], s60 offen  lds
    s_add_u32 s60, s60, 10240
    s_mov_b32 m0, 137216
    s_nop 0
    buffer_load_dwordx4 v45, s[88:91], s60 offen  lds
    s_add_u32 s60, s60, 10240
    s_mov_b32 m0, 138240
    s_nop 0
    buffer_load_dwordx4 v45, s[88:91], s60 offen  lds
L_rpd_46:
    s_and_b32 s60, s10, 0x7fffffff
    s_bitcmp1_b32 s10, 31
    s_cbranch_scc1 L_rpw_47
    s_mov_b32 m0, 139264
    s_nop 0
    buffer_load_dwordx4 v46, s[92:95], s60 offen  lds
    s_add_u32 s60, s60, 10240
    s_mov_b32 m0, 140288
    s_nop 0
    buffer_load_dwordx4 v46, s[92:95], s60 offen  lds
    s_add_u32 s60, s60, 10240
    s_mov_b32 m0, 141312
    s_nop 0
    buffer_load_dwordx4 v46, s[92:95], s60 offen  lds
    s_add_u32 s60, s60, 10240
    s_mov_b32 m0, 142336
    s_nop 0
    buffer_load_dwordx4 v46, s[92:95], s60 offen  lds
    s_branch L_rpd_48
L_rpw_47:
    s_mov_b32 m0, 139264
    s_nop 0
    buffer_load_dwordx4 v46, s[88:91], s60 offen  lds
    s_add_u32 s60, s60, 10240
    s_mov_b32 m0, 140288
    s_nop 0
    buffer_load_dwordx4 v46, s[88:91], s60 offen  lds
    s_add_u32 s60, s60, 10240
    s_mov_b32 m0, 141312
    s_nop 0
    buffer_load_dwordx4 v46, s[88:91], s60 offen  lds
    s_add_u32 s60, s60, 10240
    s_mov_b32 m0, 142336
    s_nop 0
    buffer_load_dwordx4 v46, s[88:91], s60 offen  lds
L_rpd_48:
    s_and_b32 s60, s11, 0x7fffffff
    s_bitcmp1_b32 s11, 31
    s_cbranch_scc1 L_rpw_49
    s_mov_b32 m0, 143360
    s_nop 0
    buffer_load_dwordx4 v47, s[92:95], s60 offen  lds
    s_add_u32 s60, s60, 10240
    s_mov_b32 m0, 144384
    s_nop 0
    buffer_load_dwordx4 v47, s[92:95], s60 offen  lds
    s_add_u32 s60, s60, 10240
    s_mov_b32 m0, 145408
    s_nop 0
    buffer_load_dwordx4 v47, s[92:95], s60 offen  lds
    s_add_u32 s60, s60, 10240
    s_mov_b32 m0, 146432
    s_nop 0
    buffer_load_dwordx4 v47, s[92:95], s60 offen  lds
    s_branch L_rpd_50
L_rpw_49:
    s_mov_b32 m0, 143360
    s_nop 0
    buffer_load_dwordx4 v47, s[88:91], s60 offen  lds
    s_add_u32 s60, s60, 10240
    s_mov_b32 m0, 144384
    s_nop 0
    buffer_load_dwordx4 v47, s[88:91], s60 offen  lds
    s_add_u32 s60, s60, 10240
    s_mov_b32 m0, 145408
    s_nop 0
    buffer_load_dwordx4 v47, s[88:91], s60 offen  lds
    s_add_u32 s60, s60, 10240
    s_mov_b32 m0, 146432
    s_nop 0
    buffer_load_dwordx4 v47, s[88:91], s60 offen  lds
L_rpd_50:
L_bo_42:
    v_mov_b32 v28, 0
    buffer_load_dword v29, v28, s[96:99], 0 offen sc1
    s_barrier
    s_cmp_eq_u32 s74, 1
    s_cbranch_scc0 L_gw_51
    v_mov_b32 v32, v106
    v_mov_b32 v33, v106
    v_mov_b32 v34, v106
    v_mov_b32 v35, v106
    ds_write_b128 v26, v[32:35]
    s_waitcnt lgkmcnt(0)
L_gw_51:
    s_barrier
    s_cmp_eq_u32 s74, 1
    s_cbranch_scc0 L_gw_52
    v_mov_b32 v32, v107
    v_mov_b32 v33, v107
    v_mov_b32 v34, v107
    v_mov_b32 v35, v107
    ds_write_b128 v27, v[32:35]
    s_waitcnt lgkmcnt(0)
L_gw_52:
    s_barrier
    s_cmp_eq_u32 s74, 1
    s_cbranch_scc0 L_gw_53
    v_mov_b32 v32, v108
    v_mov_b32 v33, v108
    v_mov_b32 v34, v108
    v_mov_b32 v35, v108
    ds_write_b128 v24, v[32:35]
    s_waitcnt lgkmcnt(0)
L_gw_53:
    s_cmp_eq_u32 s77, 0
    s_cbranch_scc1 L_bo_54
    s_waitcnt vmcnt(13)
    ds_read_b64_tr_b16 v[176:177], v140 offset:0
    ds_read_b64_tr_b16 v[178:179], v141 offset:0
    ds_read_b64_tr_b16 v[180:181], v140 offset:32
    ds_read_b64_tr_b16 v[182:183], v141 offset:32
    ds_read_b64_tr_b16 v[184:185], v140 offset:64
    ds_read_b64_tr_b16 v[186:187], v141 offset:64
    ds_read_b64_tr_b16 v[188:189], v140 offset:96
    ds_read_b64_tr_b16 v[190:191], v141 offset:96
    v_readlane_b32 s16, v170, 0
    v_readlane_b32 s17, v170, 1
    v_readlane_b32 s18, v170, 2
    v_readlane_b32 s19, v170, 3
    s_waitcnt lgkmcnt(0)
    s_nop 0
    buffer_store_dwordx4 v[176:179], v142, s[44:47], s16 offen sc1
    buffer_store_dwordx4 v[180:183], v142, s[44:47], s17 offen sc1
    buffer_store_dwordx4 v[184:187], v142, s[44:47], s18 offen sc1
    buffer_store_dwordx4 v[188:191], v142, s[44:47], s19 offen sc1
    s_waitcnt vmcnt(13)
    ds_read_b64_tr_b16 v[192:193], v143 offset:0
    ds_read_b64_tr_b16 v[194:195], v144 offset:0
    ds_read_b64_tr_b16 v[196:197], v143 offset:32
    ds_read_b64_tr_b16 v[198:199], v144 offset:32
    ds_read_b64_tr_b16 v[200:201], v143 offset:64
    ds_read_b64_tr_b16 v[202:203], v144 offset:64
    ds_read_b64_tr_b16 v[204:205], v143 offset:96
    ds_read_b64_tr_b16 v[206:207], v144 offset:96
    v_readlane_b32 s16, v170, 4
    v_readlane_b32 s17, v170, 5
    v_readlane_b32 s18, v170, 6
    v_readlane_b32 s19, v170, 7
    s_waitcnt lgkmcnt(0)
    s_nop 0
    buffer_store_dwordx4 v[192:195], v145, s[44:47], s16 offen sc1
    buffer_store_dwordx4 v[196:199], v145, s[44:47], s17 offen sc1
    buffer_store_dwordx4 v[200:203], v145, s[44:47], s18 offen sc1
    buffer_store_dwordx4 v[204:207], v145, s[44:47], s19 offen sc1
L_bo_54:
    s_barrier
    s_cmp_eq_u32 s74, 1
    s_cbranch_scc0 L_gw_55
    v_mov_b32 v32, v109
    v_mov_b32 v33, v109
    v_mov_b32 v34, v109
    v_mov_b32 v35, v109
    ds_write_b128 v25, v[32:35]
    s_waitcnt lgkmcnt(0)
L_gw_55:
    s_cmp_eq_u32 s77, 0
    s_cbranch_scc1 L_bo_56
    s_waitcnt vmcnt(13)
    ds_read_b64_tr_b16 v[176:177], v146 offset:0
    ds_read_b64_tr_b16 v[178:179], v147 offset:0
    ds_read_b64_tr_b16 v[180:181], v146 offset:32
    ds_read_b64_tr_b16 v[182:183], v147 offset:32
    ds_read_b64_tr_b16 v[184:185], v146 offset:64
    ds_read_b64_tr_b16 v[186:187], v147 offset:64
    ds_read_b64_tr_b16 v[188:189], v146 offset:96
    ds_read_b64_tr_b16 v[190:191], v147 offset:96
    v_readlane_b32 s16, v170, 8
    v_readlane_b32 s17, v170, 9
    v_readlane_b32 s18, v170, 10
    v_readlane_b32 s19, v170, 11
    s_waitcnt lgkmcnt(0)
    s_nop 0
    buffer_store_dwordx4 v[176:179], v148, s[44:47], s16 offen sc1
    buffer_store_dwordx4 v[180:183], v148, s[44:47], s17 offen sc1
    buffer_store_dwordx4 v[184:187], v148, s[44:47], s18 offen sc1
    buffer_store_dwordx4 v[188:191], v148, s[44:47], s19 offen sc1
    s_waitcnt vmcnt(13)
    ds_read_b64_tr_b16 v[192:193], v149 offset:0
    ds_read_b64_tr_b16 v[194:195], v150 offset:0
    ds_read_b64_tr_b16 v[196:197], v149 offset:32
    ds_read_b64_tr_b16 v[198:199], v150 offset:32
    ds_read_b64_tr_b16 v[200:201], v149 offset:64
    ds_read_b64_tr_b16 v[202:203], v150 offset:64
    ds_read_b64_tr_b16 v[204:205], v149 offset:96
    ds_read_b64_tr_b16 v[206:207], v150 offset:96
    v_readlane_b32 s16, v170, 12
    v_readlane_b32 s17, v170, 13
    v_readlane_b32 s18, v170, 14
    v_readlane_b32 s19, v170, 15
    s_waitcnt lgkmcnt(0)
    s_nop 0
    buffer_store_dwordx4 v[192:195], v151, s[44:47], s16 offen sc1
    buffer_store_dwordx4 v[196:199], v151, s[44:47], s17 offen sc1
    buffer_store_dwordx4 v[200:203], v151, s[44:47], s18 offen sc1
    buffer_store_dwordx4 v[204:207], v151, s[44:47], s19 offen sc1
L_bo_56:
    s_barrier
    s_cmp_eq_u32 s74, 1
    s_cbranch_scc0 L_gw_57
    v_mov_b32 v32, v110
    v_mov_b32 v33, v110
    v_mov_b32 v34, v110
    v_mov_b32 v35, v110
    ds_write_b128 v26, v[32:35]
    s_waitcnt lgkmcnt(0)
L_gw_57:
    s_barrier
    s_cmp_eq_u32 s74, 1
    s_cbranch_scc0 L_gw_58
    v_mov_b32 v32, v111
    v_mov_b32 v33, v111
    v_mov_b32 v34, v111
    v_mov_b32 v35, v111
    ds_write_b128 v27, v[32:35]
    s_waitcnt lgkmcnt(0)
L_gw_58:
    s_barrier
    s_cmp_eq_u32 s74, 1
    s_cbranch_scc0 L_gw_59
    v_mov_b32 v32, v112
    v_mov_b32 v33, v112
    v_mov_b32 v34, v112
    v_mov_b32 v35, v112
    ds_write_b128 v24, v[32:35]
    s_waitcnt lgkmcnt(0)
L_gw_59:
    s_barrier
    s_cmp_eq_u32 s74, 1
    s_cbranch_scc0 L_gw_60
    v_mov_b32 v32, v113
    v_mov_b32 v33, v113
    v_mov_b32 v34, v113
    v_mov_b32 v35, v113
    ds_write_b128 v25, v[32:35]
    s_waitcnt lgkmcnt(0)
L_gw_60:
    s_waitcnt vmcnt(0)
    s_mov_b32 s56, 0x40000
L_rcl_61:
    v_cmp_eq_u32 vcc, 1, v29
    s_cbranch_vccnz L_rck_62
    buffer_load_dword v29, v28, s[96:99], 0 offen sc1
    s_waitcnt vmcnt(0)
    s_sub_u32 s56, s56, 1
    s_cmp_lg_u32 s56, 0
    s_cbranch_scc1 L_rcl_61
L_rck_62:
    s_cmp_eq_u32 s77, 0
    s_cbranch_scc1 L_bo_63
    s_lshl_b32 s56, s75, 6
    s_add_u32 s56, s56, 13713408
    v_mov_b32 v30, 1
    s_mov_b64 exec, 1
    buffer_store_dword v30, v28, s[44:47], s56 offen sc1
    s_mov_b64 exec, -1
L_bo_63:
    s_barrier
    s_cmp_eq_u32 s74, 1
    s_cbranch_scc0 L_gw_64
    v_mov_b32 v32, v114
    v_mov_b32 v33, v114
    v_mov_b32 v34, v114
    v_mov_b32 v35, v114
    ds_write_b128 v26, v[32:35]
    s_waitcnt lgkmcnt(0)
L_gw_64:
    s_barrier
    s_cmp_eq_u32 s74, 1
    s_cbranch_scc0 L_gw_65
    v_mov_b32 v32, v115
    v_mov_b32 v33, v115
    v_mov_b32 v34, v115
    v_mov_b32 v35, v115
    ds_write_b128 v27, v[32:35]
    s_waitcnt lgkmcnt(0)
L_gw_65:
    s_barrier
    s_cmp_eq_u32 s74, 1
    s_cbranch_scc0 L_gw_66
    v_mov_b32 v32, v116
    v_mov_b32 v33, v116
    v_mov_b32 v34, v116
    v_mov_b32 v35, v116
    ds_write_b128 v24, v[32:35]
    s_waitcnt lgkmcnt(0)
L_gw_66:
    s_barrier
    s_cmp_eq_u32 s74, 1
    s_cbranch_scc0 L_gw_67
    v_mov_b32 v32, v117
    v_mov_b32 v33, v117
    v_mov_b32 v34, v117
    v_mov_b32 v35, v117
    ds_write_b128 v25, v[32:35]
    s_waitcnt lgkmcnt(0)
L_gw_67:
    s_barrier
    s_cmp_eq_u32 s74, 1
    s_cbranch_scc0 L_gw_68
    v_mov_b32 v32, v118
    v_mov_b32 v33, v118
    v_mov_b32 v34, v118
    v_mov_b32 v35, v118
    ds_write_b128 v26, v[32:35]
    s_waitcnt lgkmcnt(0)
L_gw_68:
    s_barrier
    s_cmp_eq_u32 s74, 1
    s_cbranch_scc0 L_gw_69
    v_mov_b32 v32, v119
    v_mov_b32 v33, v119
    v_mov_b32 v34, v119
    v_mov_b32 v35, v119
    ds_write_b128 v27, v[32:35]
    s_waitcnt lgkmcnt(0)
L_gw_69:
    s_mov_b32 s56, 13713408
    buffer_load_dword v2, v232, s[44:47], s56 offen sc1
    s_barrier
    s_barrier
    s_setprio 0
    s_waitcnt vmcnt(0)
    s_mov_b32 s57, 0x40000
    s_lshl_b32 s58, s64, 1
L_wpl_70:
    v_cmp_gt_u32 s[88:89], s58, v1
    v_cmp_ne_u32 vcc, 1, v2
    s_nop 3
    s_and_b64 vcc, vcc, s[88:89]
    s_cbranch_vccz L_wpk_71
    s_mov_b32 s56, 13713408
    buffer_load_dword v2, v232, s[44:47], s56 offen sc1
    s_waitcnt vmcnt(0)
    s_sub_u32 s57, s57, 1
    s_cmp_lg_u32 s57, 0
    s_cbranch_scc1 L_wpl_70
L_wpk_71:
    v_lshlrev_b32 v4, 4, v1
    s_add_u32 s65, s82, 0
    s_sub_u32 s67, s65, s64
    s_cmp_ge_u32 s65, s64
    s_cselect_b32 s65, s67, s65
    s_mul_i32 s67, s65, 5120
    s_add_u32 s67, s67, s81
    s_add_u32 s68, s67, 4096
    buffer_load_dwordx4 v[136:139], v4, s[44:47], s67 offen offset:0 sc1
    buffer_load_dwordx4 v[140:143], v4, s[44:47], s67 offen offset:1024 sc1
    buffer_load_dwordx4 v[144:147], v4, s[44:47], s67 offen offset:2048 sc1
    buffer_load_dwordx4 v[148:151], v4, s[44:47], s67 offen offset:3072 sc1
    buffer_load_dwordx4 v[152:155], v4, s[44:47], s68 offen sc1
    s_add_u32 s65, s82, 1
    s_sub_u32 s67, s65, s64
    s_cmp_ge_u32 s65, s64
    s_cselect_b32 s65, s67, s65
    s_mul_i32 s67, s65, 5120
    s_add_u32 s67, s67, s81
    s_add_u32 s68, s67, 4096
    buffer_load_dwordx4 v[156:159], v4, s[44:47], s67 offen offset:0 sc1
    buffer_load_dwordx4 v[160:163], v4, s[44:47], s67 offen offset:1024 sc1
    buffer_load_dwordx4 v[164:167], v4, s[44:47], s67 offen offset:2048 sc1
    buffer_load_dwordx4 v[168:171], v4, s[44:47], s67 offen offset:3072 sc1
    buffer_load_dwordx4 v[172:175], v4, s[44:47], s68 offen sc1
    s_add_u32 s65, s82, 2
    s_sub_u32 s67, s65, s64
    s_cmp_ge_u32 s65, s64
    s_cselect_b32 s65, s67, s65
    s_mul_i32 s67, s65, 5120
    s_add_u32 s67, s67, s81
    s_add_u32 s68, s67, 4096
    buffer_load_dwordx4 v[176:179], v4, s[44:47], s67 offen offset:0 sc1
    buffer_load_dwordx4 v[180:183], v4, s[44:47], s67 offen offset:1024 sc1
    buffer_load_dwordx4 v[184:187], v4, s[44:47], s67 offen offset:2048 sc1
    buffer_load_dwordx4 v[188:191], v4, s[44:47], s67 offen offset:3072 sc1
    buffer_load_dwordx4 v[192:195], v4, s[44:47], s68 offen sc1
    s_add_u32 s65, s82, 3
    s_sub_u32 s67, s65, s64
    s_cmp_ge_u32 s65, s64
    s_cselect_b32 s65, s67, s65
    s_mul_i32 s67, s65, 5120
    s_add_u32 s67, s67, s81
    s_add_u32 s68, s67, 4096
    buffer_load_dwordx4 v[196:199], v4, s[44:47], s67 offen offset:0 sc1
    buffer_load_dwordx4 v[200:203], v4, s[44:47], s67 offen offset:1024 sc1
    buffer_load_dwordx4 v[204:207], v4, s[44:47], s67 offen offset:2048 sc1
    buffer_load_dwordx4 v[208:211], v4, s[44:47], s67 offen offset:3072 sc1
    buffer_load_dwordx4 v[212:215], v4, s[44:47], s68 offen sc1
    s_cmp_eq_u32 s33, 1
    s_cbranch_scc1 L_attn
    s_branch L_bar3
L_phase3:
    s_sub_u32 s3, s64, 4
    s_and_b32 s69, s78, 3
    s_lshl_b32 s69, s69, 1
    s_sub_u32 s56, s69, s3
    s_cmp_ge_u32 s69, s3
    s_cselect_b32 s69, s56, s69
    s_cmp_ge_u32 s32, 4
    s_cbranch_scc0 L_hp_73
    s_setprio 1
L_hp_73:
    v_lshlrev_b32 v4, 4, v1
    s_cmp_eq_u32 s64, 9
    s_cselect_b32 s62, 2147483648, 0
    v_or_b32 v5, s62, v4
    s_cmp_lt_u32 s32, 2
    s_cbranch_scc1 L_fo_74
    s_add_u32 s56, s32, 2
    s_sub_u32 s57, s32, 4
    s_cmp_ge_u32 s32, 4
    s_cselect_b32 s56, s57, s56
    s_mul_i32 s58, s56, 9
    s_lshr_b32 s60, s78, 1
    s_mul_i32 s60, s60, 7
    s_add_u32 s60, s60, 144
    s_lshr_b32 s61, s58, 3
    s_add_u32 s61, s61, s60
    s_add_u32 s58, s58, 8
    s_lshr_b32 s58, s58, 3
    s_add_u32 s58, s58, s60
    v_mov_b32 v2, s61
    v_mov_b32 v7, s58
    v_cmp_gt_u32 vcc, 4, v1
    s_nop 1
    v_cndmask_b32 v2, v7, v2, vcc
    s_branch L_fd_75
L_fo_74:
    s_lshl_b32 s60, s78, 6
    s_mul_i32 s61, s60, 575
    s_lshr_b32 s61, s61, 16
    s_add_u32 s60, s60, 63
    s_mul_i32 s60, s60, 575
    s_lshr_b32 s60, s60, 16
    s_lshl_b32 s61, s61, 3
    s_lshl_b32 s60, s60, 3
    s_lshl_b32 s57, s32, 2
    s_add_u32 s61, s61, s57
    s_add_u32 s60, s60, s57
    v_mov_b32 v2, s61
    v_mov_b32 v7, s60
    v_cmp_gt_u32 vcc, 4, v1
    s_nop 1
    v_cndmask_b32 v2, v7, v2, vcc
    v_and_b32 v7, 3, v1
    v_add_u32 v2, v2, v7
L_fd_75:
    v_lshlrev_b32 v2, 6, v2
    v_mov_b32 v7, 2147483648
    v_cmp_gt_u32 vcc, 8, v1
    s_nop 1
    v_cndmask_b32 v2, v7, v2, vcc
    v_mov_b32 v7, 0
    v_cmp_gt_u32 vcc, 8, v1
    s_nop 1
    v_cndmask_b32 v7, 0, 1, vcc
    s_mov_b32 s57, 13697024
    s_cmp_ge_u32 s32, 4
    s_cbranch_scc1 L_b4_76
    s_cmp_eq_u32 s33, 1
    s_cbranch_scc1 L_b4_76
    v_lshlrev_b32 v4, 4, v1
    s_add_u32 s65, s82, 0
    s_sub_u32 s67, s65, s64
    s_cmp_ge_u32 s65, s64
    s_cselect_b32 s65, s67, s65
    s_mul_i32 s67, s65, 5120
    s_add_u32 s67, s67, s81
    s_add_u32 s68, s67, 4096
    buffer_load_dwordx4 v[136:139], v4, s[44:47], s67 offen offset:0 sc1
    buffer_load_dwordx4 v[140:143], v4, s[44:47], s67 offen offset:1024 sc1
    buffer_load_dwordx4 v[144:147], v4, s[44:47], s67 offen offset:2048 sc1
    buffer_load_dwordx4 v[148:151], v4, s[44:47], s67 offen offset:3072 sc1
    buffer_load_dwordx4 v[152:155], v4, s[44:47], s68 offen sc1
    s_add_u32 s65, s82, 1
    s_sub_u32 s67, s65, s64
    s_cmp_ge_u32 s65, s64
    s_cselect_b32 s65, s67, s65
    s_mul_i32 s67, s65, 5120
    s_add_u32 s67, s67, s81
    s_add_u32 s68, s67, 4096
    buffer_load_dwordx4 v[156:159], v4, s[44:47], s67 offen offset:0 sc1
    buffer_load_dwordx4 v[160:163], v4, s[44:47], s67 offen offset:1024 sc1
    buffer_load_dwordx4 v[164:167], v4, s[44:47], s67 offen offset:2048 sc1
    buffer_load_dwordx4 v[168:171], v4, s[44:47], s67 offen offset:3072 sc1
    buffer_load_dwordx4 v[172:175], v4, s[44:47], s68 offen sc1
    s_add_u32 s65, s82, 2
    s_sub_u32 s67, s65, s64
    s_cmp_ge_u32 s65, s64
    s_cselect_b32 s65, s67, s65
    s_mul_i32 s67, s65, 5120
    s_add_u32 s67, s67, s81
    s_add_u32 s68, s67, 4096
    buffer_load_dwordx4 v[176:179], v4, s[44:47], s67 offen offset:0 sc1
    buffer_load_dwordx4 v[180:183], v4, s[44:47], s67 offen offset:1024 sc1
    buffer_load_dwordx4 v[184:187], v4, s[44:47], s67 offen offset:2048 sc1
    buffer_load_dwordx4 v[188:191], v4, s[44:47], s67 offen offset:3072 sc1
    buffer_load_dwordx4 v[192:195], v4, s[44:47], s68 offen sc1
    s_add_u32 s65, s82, 3
    s_sub_u32 s67, s65, s64
    s_cmp_ge_u32 s65, s64
    s_cselect_b32 s65, s67, s65
    s_mul_i32 s67, s65, 5120
    s_add_u32 s67, s67, s81
    s_add_u32 s68, s67, 4096
    buffer_load_dwordx4 v[196:199], v4, s[44:47], s67 offen offset:0 sc1
    buffer_load_dwordx4 v[200:203], v4, s[44:47], s67 offen offset:1024 sc1
    buffer_load_dwordx4 v[204:207], v4, s[44:47], s67 offen offset:2048 sc1
    buffer_load_dwordx4 v[208:211], v4, s[44:47], s67 offen offset:3072 sc1
    buffer_load_dwordx4 v[212:215], v4, s[44:47], s68 offen sc1
L_b4_76:
    buffer_load_dword v6, v2, s[44:47], s57 offen sc1
    s_add_u32 s65, s82, 4
    s_sub_u32 s67, s65, s64
    s_cmp_ge_u32 s65, s64
    s_cselect_b32 s65, s67, s65
    s_mul_i32 s67, s65, 5120
    s_add_u32 s67, s67, s81
    s_add_u32 s68, s67, 4096
    buffer_load_dwordx4 v[216:219], v4, s[44:47], s67 offen offset:0 sc1
    buffer_load_dwordx4 v[220:223], v4, s[44:47], s67 offen offset:1024 sc1
    buffer_load_dwordx4 v[224:227], v4, s[44:47], s67 offen offset:2048 sc1
    buffer_load_dwordx4 v[228:231], v4, s[44:47], s67 offen offset:3072 sc1
    buffer_load_dwordx4 v[232:235], v4, s[44:47], s68 offen sc1
    s_add_u32 s65, s82, 5
    s_sub_u32 s67, s65, s64
    s_cmp_ge_u32 s65, s64
    s_cselect_b32 s65, s67, s65
    s_mul_i32 s67, s65, 5120
    s_add_u32 s67, s67, s81
    s_add_u32 s68, s67, 4096
    buffer_load_dwordx4 v[236:239], v4, s[44:47], s67 offen offset:0 sc1
    buffer_load_dwordx4 v[240:243], v4, s[44:47], s67 offen offset:1024 sc1
    buffer_load_dwordx4 v[244:247], v4, s[44:47], s67 offen offset:2048 sc1
    buffer_load_dwordx4 v[248:251], v4, s[44:47], s67 offen offset:3072 sc1
    buffer_load_dwordx4 v[252:255], v4, s[44:47], s68 offen sc1
    v_mov_b32 v8, 0
    v_mov_b32 v9, 0
    v_mov_b32 v10, 0
    v_mov_b32 v11, 0
    v_mov_b32 v12, 0
    v_mov_b32 v13, 0
    v_mov_b32 v14, 0
    v_mov_b32 v15, 0
    v_mov_b32 v16, 0
    v_mov_b32 v17, 0
    v_mov_b32 v18, 0
    v_mov_b32 v19, 0
    v_mov_b32 v20, 0
    v_mov_b32 v21, 0
    v_mov_b32 v22, 0
    v_mov_b32 v23, 0
    v_mov_b32 v24, 0
    v_mov_b32 v25, 0
    v_mov_b32 v26, 0
    v_mov_b32 v27, 0
    v_mov_b32 v28, 0
    v_mov_b32 v29, 0
    v_mov_b32 v30, 0
    v_mov_b32 v31, 0
    v_mov_b32 v32, 0
    v_mov_b32 v33, 0
    v_mov_b32 v34, 0
    v_mov_b32 v35, 0
    v_mov_b32 v36, 0
    v_mov_b32 v37, 0
    v_mov_b32 v38, 0
    v_mov_b32 v39, 0
    v_mov_b32 v40, 0
    v_mov_b32 v41, 0
    v_mov_b32 v42, 0
    v_mov_b32 v43, 0
    v_mov_b32 v44, 0
    v_mov_b32 v45, 0
    v_mov_b32 v46, 0
    v_mov_b32 v47, 0
    v_mov_b32 v48, 0
    v_mov_b32 v49, 0
    v_mov_b32 v50, 0
    v_mov_b32 v51, 0
    v_mov_b32 v52, 0
    v_mov_b32 v53, 0
    v_mov_b32 v54, 0
    v_mov_b32 v55, 0
    v_mov_b32 v56, 0
    v_mov_b32 v57, 0
    v_mov_b32 v58, 0
    v_mov_b32 v59, 0
    v_mov_b32 v60, 0
    v_mov_b32 v61, 0
    v_mov_b32 v62, 0
    v_mov_b32 v63, 0
    v_mov_b32 v64, 0
    v_mov_b32 v65, 0
    v_mov_b32 v66, 0
    v_mov_b32 v67, 0
    v_mov_b32 v68, 0
    v_mov_b32 v69, 0
    v_mov_b32 v70, 0
    v_mov_b32 v71, 0
    v_mov_b32 v72, 0
    v_mov_b32 v73, 0
    v_mov_b32 v74, 0
    v_mov_b32 v75, 0
    v_mov_b32 v76, 0
    v_mov_b32 v77, 0
    v_mov_b32 v78, 0
    v_mov_b32 v79, 0
    v_mov_b32 v80, 0
    v_mov_b32 v81, 0
    v_mov_b32 v82, 0
    v_mov_b32 v83, 0
    v_mov_b32 v84, 0
    v_mov_b32 v85, 0
    v_mov_b32 v86, 0
    v_mov_b32 v87, 0
    s_waitcnt vmcnt(10)
    s_mov_b32 s56, 0x40000
L_poll_77:
    v_cmp_ne_u32 vcc, v6, v7
    s_cbranch_vccz L_pollok_78
    buffer_load_dword v6, v2, s[44:47], s57 offen sc1
    s_waitcnt vmcnt(0)
    s_sub_u32 s56, s56, 1
    s_cmp_lg_u32 s56, 0
    s_cbranch_scc1 L_poll_77
L_pollok_78:
    s_add_u32 s66, s82, 0
    s_sub_u32 s70, s66, s64
    s_cmp_ge_u32 s66, s64
    s_cselect_b32 s66, s70, s66
    s_lshl_b32 s70, s66, 12
    s_add_u32 s70, s70, s80
    buffer_load_dwordx4 v[88:91], v4, s[44:47], s70 offen offset:0 sc1
    buffer_load_dwordx4 v[92:95], v4, s[44:47], s70 offen offset:1024 sc1
    buffer_load_dwordx4 v[96:99], v4, s[44:47], s70 offen offset:2048 sc1
    buffer_load_dwordx4 v[100:103], v4, s[44:47], s70 offen offset:3072 sc1
    s_add_u32 s66, s82, 1
    s_sub_u32 s70, s66, s64
    s_cmp_ge_u32 s66, s64
    s_cselect_b32 s66, s70, s66
    s_lshl_b32 s70, s66, 12
    s_add_u32 s70, s70, s80
    buffer_load_dwordx4 v[104:107], v4, s[44:47], s70 offen offset:0 sc1
    buffer_load_dwordx4 v[108:111], v4, s[44:47], s70 offen offset:1024 sc1
    buffer_load_dwordx4 v[112:115], v4, s[44:47], s70 offen offset:2048 sc1
    buffer_load_dwordx4 v[116:119], v4, s[44:47], s70 offen offset:3072 sc1
    s_lshl_b32 s58, s78, 8
    s_add_u32 s58, s58, 13631488
    v_lshlrev_b32 v2, 2, v1
    s_cmp_eq_u32 s32, 0
    s_cselect_b32 s59, 0, 2147483648
    v_or_b32 v2, s59, v2
    buffer_load_dword v3, v2, s[44:47], s58 offen sc1
    s_waitcnt vmcnt(5)
    v_mfma_f32_16x16x32_bf16 v[8:11], v[136:139], v[88:91], v[8:11]
    s_add_u32 s66, s82, 2
    s_sub_u32 s70, s66, s64
    s_cmp_ge_u32 s66, s64
    s_cselect_b32 s66, s70, s66
    v_mfma_f32_16x16x32_bf16 v[12:15], v[136:139], v[92:95], v[12:15]
    s_lshl_b32 s70, s66, 12
    s_add_u32 s70, s70, s80
    s_add_u32 s65, s82, 6
    s_sub_u32 s67, s65, s64
    v_mfma_f32_16x16x32_bf16 v[16:19], v[136:139], v[96:99], v[16:19]
    s_cmp_ge_u32 s65, s64
    s_cselect_b32 s65, s67, s65
    s_mul_i32 s67, s65, 5120
    s_add_u32 s67, s67, s81
    v_mfma_f32_16x16x32_bf16 v[20:23], v[136:139], v[100:103], v[20:23]
    s_add_u32 s68, s67, 4096
    buffer_load_dwordx4 v[120:123], v4, s[44:47], s70 offen offset:0 sc1
    buffer_load_dwordx4 v[136:139], v4, s[44:47], s67 offen offset:0 sc1
    v_mfma_f32_16x16x32_bf16 v[24:27], v[140:143], v[88:91], v[24:27]
    v_mfma_f32_16x16x32_bf16 v[28:31], v[140:143], v[92:95], v[28:31]
    v_mfma_f32_16x16x32_bf16 v[32:35], v[140:143], v[96:99], v[32:35]
    v_mfma_f32_16x16x32_bf16 v[36:39], v[140:143], v[100:103], v[36:39]
    buffer_load_dwordx4 v[124:127], v4, s[44:47], s70 offen offset:1024 sc1
    buffer_load_dwordx4 v[140:143], v4, s[44:47], s67 offen offset:1024 sc1
    v_mfma_f32_16x16x32_bf16 v[40:43], v[144:147], v[88:91], v[40:43]
    v_mfma_f32_16x16x32_bf16 v[44:47], v[144:147], v[92:95], v[44:47]
    v_mfma_f32_16x16x32_bf16 v[48:51], v[144:147], v[96:99], v[48:51]
    v_mfma_f32_16x16x32_bf16 v[52:55], v[144:147], v[100:103], v[52:55]
    buffer_load_dwordx4 v[128:131], v4, s[44:47], s70 offen offset:2048 sc1
    buffer_load_dwordx4 v[144:147], v4, s[44:47], s67 offen offset:2048 sc1
    v_mfma_f32_16x16x32_bf16 v[56:59], v[148:151], v[88:91], v[56:59]
    v_mfma_f32_16x16x32_bf16 v[60:63], v[148:151], v[92:95], v[60:63]
    v_mfma_f32_16x16x32_bf16 v[64:67], v[148:151], v[96:99], v[64:67]
    v_mfma_f32_16x16x32_bf16 v[68:71], v[148:151], v[100:103], v[68:71]
    buffer_load_dwordx4 v[132:135], v4, s[44:47], s70 offen offset:3072 sc1
    buffer_load_dwordx4 v[148:151], v4, s[44:47], s67 offen offset:3072 sc1
    v_mfma_f32_16x16x32_bf16 v[72:75], v[152:155], v[88:91], v[72:75]
    v_mfma_f32_16x16x32_bf16 v[76:79], v[152:155], v[92:95], v[76:79]
    v_mfma_f32_16x16x32_bf16 v[80:83], v[152:155], v[96:99], v[80:83]
    v_mfma_f32_16x16x32_bf16 v[84:87], v[152:155], v[100:103], v[84:87]
    buffer_load_dwordx4 v[152:155], v4, s[44:47], s68 offen sc1
    s_waitcnt vmcnt(10)
    v_mfma_f32_16x16x32_bf16 v[8:11], v[156:159], v[104:107], v[8:11]
    s_add_u32 s66, s82, 3
    s_sub_u32 s70, s66, s64
    s_cmp_ge_u32 s66, s64
    s_cselect_b32 s66, s70, s66
    v_mfma_f32_16x16x32_bf16 v[12:15], v[156:159], v[108:111], v[12:15]
    s_lshl_b32 s70, s66, 12
    s_add_u32 s70, s70, s80
    s_add_u32 s65, s82, 7
    s_sub_u32 s67, s65, s64
    v_mfma_f32_16x16x32_bf16 v[16:19], v[156:159], v[112:115], v[16:19]
    s_cmp_ge_u32 s65, s64
    s_cselect_b32 s65, s67, s65
    s_mul_i32 s67, s65, 5120
    s_add_u32 s67, s67, s81
    v_mfma_f32_16x16x32_bf16 v[20:23], v[156:159], v[116:119], v[20:23]
    s_add_u32 s68, s67, 4096
    buffer_load_dwordx4 v[88:91], v4, s[44:47], s70 offen offset:0 sc1
    buffer_load_dwordx4 v[156:159], v4, s[44:47], s67 offen offset:0 sc1
    v_mfma_f32_16x16x32_bf16 v[24:27], v[160:163], v[104:107], v[24:27]
    v_mfma_f32_16x16x32_bf16 v[28:31], v[160:163], v[108:111], v[28:31]
    v_mfma_f32_16x16x32_bf16 v[32:35], v[160:163], v[112:115], v[32:35]
    v_mfma_f32_16x16x32_bf16 v[36:39], v[160:163], v[116:119], v[36:39]
    buffer_load_dwordx4 v[92:95], v4, s[44:47], s70 offen offset:1024 sc1
    buffer_load_dwordx4 v[160:163], v4, s[44:47], s67 offen offset:1024 sc1
    v_mfma_f32_16x16x32_bf16 v[40:43], v[164:167], v[104:107], v[40:43]
    v_mfma_f32_16x16x32_bf16 v[44:47], v[164:167], v[108:111], v[44:47]
    v_mfma_f32_16x16x32_bf16 v[48:51], v[164:167], v[112:115], v[48:51]
    v_mfma_f32_16x16x32_bf16 v[52:55], v[164:167], v[116:119], v[52:55]
    buffer_load_dwordx4 v[96:99], v4, s[44:47], s70 offen offset:2048 sc1
    buffer_load_dwordx4 v[164:167], v4, s[44:47], s67 offen offset:2048 sc1
    v_mfma_f32_16x16x32_bf16 v[56:59], v[168:171], v[104:107], v[56:59]
    v_mfma_f32_16x16x32_bf16 v[60:63], v[168:171], v[108:111], v[60:63]
    v_mfma_f32_16x16x32_bf16 v[64:67], v[168:171], v[112:115], v[64:67]
    v_mfma_f32_16x16x32_bf16 v[68:71], v[168:171], v[116:119], v[68:71]
    buffer_load_dwordx4 v[100:103], v4, s[44:47], s70 offen offset:3072 sc1
    buffer_load_dwordx4 v[168:171], v4, s[44:47], s67 offen offset:3072 sc1
    v_mfma_f32_16x16x32_bf16 v[72:75], v[172:175], v[104:107], v[72:75]
    v_mfma_f32_16x16x32_bf16 v[76:79], v[172:175], v[108:111], v[76:79]
    v_mfma_f32_16x16x32_bf16 v[80:83], v[172:175], v[112:115], v[80:83]
    v_mfma_f32_16x16x32_bf16 v[84:87], v[172:175], v[116:119], v[84:87]
    buffer_load_dwordx4 v[172:175], v4, s[44:47], s68 offen sc1
    s_waitcnt vmcnt(11)
    v_mfma_f32_16x16x32_bf16 v[8:11], v[176:179], v[120:123], v[8:11]
    s_add_u32 s66, s82, 4
    s_sub_u32 s70, s66, s64
    s_cmp_ge_u32 s66, s64
    s_cselect_b32 s66, s70, s66
    v_mfma_f32_16x16x32_bf16 v[12:15], v[176:179], v[124:127], v[12:15]
    s_lshl_b32 s70, s66, 12
    s_add_u32 s70, s70, s80
    s_add_u32 s65, s82, 8
    s_sub_u32 s67, s65, s64
    v_mfma_f32_16x16x32_bf16 v[16:19], v[176:179], v[128:131], v[16:19]
    s_cmp_ge_u32 s65, s64
    s_cselect_b32 s65, s67, s65
    s_mul_i32 s67, s65, 5120
    s_add_u32 s67, s67, s81
    v_mfma_f32_16x16x32_bf16 v[20:23], v[176:179], v[132:135], v[20:23]
    s_add_u32 s68, s67, 4096
    buffer_load_dwordx4 v[104:107], v4, s[44:47], s70 offen offset:0 sc1
    buffer_load_dwordx4 v[176:179], v4, s[44:47], s67 offen offset:0 sc1
    v_mfma_f32_16x16x32_bf16 v[24:27], v[180:183], v[120:123], v[24:27]
    v_mfma_f32_16x16x32_bf16 v[28:31], v[180:183], v[124:127], v[28:31]
    v_mfma_f32_16x16x32_bf16 v[32:35], v[180:183], v[128:131], v[32:35]
    v_mfma_f32_16x16x32_bf16 v[36:39], v[180:183], v[132:135], v[36:39]
    buffer_load_dwordx4 v[108:111], v4, s[44:47], s70 offen offset:1024 sc1
    buffer_load_dwordx4 v[180:183], v4, s[44:47], s67 offen offset:1024 sc1
    v_mfma_f32_16x16x32_bf16 v[40:43], v[184:187], v[120:123], v[40:43]
    v_mfma_f32_16x16x32_bf16 v[44:47], v[184:187], v[124:127], v[44:47]
    v_mfma_f32_16x16x32_bf16 v[48:51], v[184:187], v[128:131], v[48:51]
    v_mfma_f32_16x16x32_bf16 v[52:55], v[184:187], v[132:135], v[52:55]
    buffer_load_dwordx4 v[112:115], v4, s[44:47], s70 offen offset:2048 sc1
    buffer_load_dwordx4 v[184:187], v4, s[44:47], s67 offen offset:2048 sc1
    v_mfma_f32_16x16x32_bf16 v[56:59], v[188:191], v[120:123], v[56:59]
    v_mfma_f32_16x16x32_bf16 v[60:63], v[188:191], v[124:127], v[60:63]
    v_mfma_f32_16x16x32_bf16 v[64:67], v[188:191], v[128:131], v[64:67]
    v_mfma_f32_16x16x32_bf16 v[68:71], v[188:191], v[132:135], v[68:71]
    buffer_load_dwordx4 v[116:119], v4, s[44:47], s70 offen offset:3072 sc1
    buffer_load_dwordx4 v[188:191], v4, s[44:47], s67 offen offset:3072 sc1
    v_mfma_f32_16x16x32_bf16 v[72:75], v[192:195], v[120:123], v[72:75]
    v_mfma_f32_16x16x32_bf16 v[76:79], v[192:195], v[124:127], v[76:79]
    v_mfma_f32_16x16x32_bf16 v[80:83], v[192:195], v[128:131], v[80:83]
    v_mfma_f32_16x16x32_bf16 v[84:87], v[192:195], v[132:135], v[84:87]
    buffer_load_dwordx4 v[192:195], v4, s[44:47], s68 offen sc1
    s_waitcnt vmcnt(11)
    v_mfma_f32_16x16x32_bf16 v[8:11], v[196:199], v[88:91], v[8:11]
    s_add_u32 s66, s82, 5
    s_sub_u32 s70, s66, s64
    s_cmp_ge_u32 s66, s64
    s_cselect_b32 s66, s70, s66
    v_mfma_f32_16x16x32_bf16 v[12:15], v[196:199], v[92:95], v[12:15]
    s_lshl_b32 s70, s66, 12
    s_add_u32 s70, s70, s80
    s_add_u32 s65, s82, 9
    s_sub_u32 s67, s65, s64
    v_mfma_f32_16x16x32_bf16 v[16:19], v[196:199], v[96:99], v[16:19]
    s_cmp_ge_u32 s65, s64
    s_cselect_b32 s65, s67, s65
    s_mul_i32 s67, s65, 5120
    s_add_u32 s67, s67, s81
    v_mfma_f32_16x16x32_bf16 v[20:23], v[196:199], v[100:103], v[20:23]
    s_add_u32 s68, s67, 4096
    buffer_load_dwordx4 v[120:123], v4, s[44:47], s70 offen offset:0 sc1
    buffer_load_dwordx4 v[196:199], v5, s[44:47], s67 offen offset:0 sc1
    v_mfma_f32_16x16x32_bf16 v[24:27], v[200:203], v[88:91], v[24:27]
    v_mfma_f32_16x16x32_bf16 v[28:31], v[200:203], v[92:95], v[28:31]
    v_mfma_f32_16x16x32_bf16 v[32:35], v[200:203], v[96:99], v[32:35]
    v_mfma_f32_16x16x32_bf16 v[36:39], v[200:203], v[100:103], v[36:39]
    buffer_load_dwordx4 v[124:127], v4, s[44:47], s70 offen offset:1024 sc1
    buffer_load_dwordx4 v[200:203], v5, s[44:47], s67 offen offset:1024 sc1
    v_mfma_f32_16x16x32_bf16 v[40:43], v[204:207], v[88:91], v[40:43]
    v_mfma_f32_16x16x32_bf16 v[44:47], v[204:207], v[92:95], v[44:47]
    v_mfma_f32_16x16x32_bf16 v[48:51], v[204:207], v[96:99], v[48:51]
    v_mfma_f32_16x16x32_bf16 v[52:55], v[204:207], v[100:103], v[52:55]
    buffer_load_dwordx4 v[128:131], v4, s[44:47], s70 offen offset:2048 sc1
    buffer_load_dwordx4 v[204:207], v5, s[44:47], s67 offen offset:2048 sc1
    v_mfma_f32_16x16x32_bf16 v[56:59], v[208:211], v[88:91], v[56:59]
    v_mfma_f32_16x16x32_bf16 v[60:63], v[208:211], v[92:95], v[60:63]
    v_mfma_f32_16x16x32_bf16 v[64:67], v[208:211], v[96:99], v[64:67]
    v_mfma_f32_16x16x32_bf16 v[68:71], v[208:211], v[100:103], v[68:71]
    buffer_load_dwordx4 v[132:135], v4, s[44:47], s70 offen offset:3072 sc1
    buffer_load_dwordx4 v[208:211], v5, s[44:47], s67 offen offset:3072 sc1
    v_mfma_f32_16x16x32_bf16 v[72:75], v[212:215], v[88:91], v[72:75]
    v_mfma_f32_16x16x32_bf16 v[76:79], v[212:215], v[92:95], v[76:79]
    v_mfma_f32_16x16x32_bf16 v[80:83], v[212:215], v[96:99], v[80:83]
    v_mfma_f32_16x16x32_bf16 v[84:87], v[212:215], v[100:103], v[84:87]
    buffer_load_dwordx4 v[212:215], v5, s[44:47], s68 offen sc1
    s_waitcnt vmcnt(11)
    v_mfma_f32_16x16x32_bf16 v[8:11], v[216:219], v[104:107], v[8:11]
    s_add_u32 s66, s82, 6
    s_sub_u32 s70, s66, s64
    v_mfma_f32_16x16x32_bf16 v[12:15], v[216:219], v[108:111], v[12:15]
    s_cmp_ge_u32 s66, s64
    s_cselect_b32 s66, s70, s66
    v_mfma_f32_16x16x32_bf16 v[16:19], v[216:219], v[112:115], v[16:19]
    s_lshl_b32 s70, s66, 12
    s_add_u32 s70, s70, s80
    v_mfma_f32_16x16x32_bf16 v[20:23], v[216:219], v[116:119], v[20:23]
    buffer_load_dwordx4 v[88:91], v4, s[44:47], s70 offen offset:0 sc1
    v_mfma_f32_16x16x32_bf16 v[24:27], v[220:223], v[104:107], v[24:27]
    v_mfma_f32_16x16x32_bf16 v[28:31], v[220:223], v[108:111], v[28:31]
    v_mfma_f32_16x16x32_bf16 v[32:35], v[220:223], v[112:115], v[32:35]
    v_mfma_f32_16x16x32_bf16 v[36:39], v[220:223], v[116:119], v[36:39]
    buffer_load_dwordx4 v[92:95], v4, s[44:47], s70 offen offset:1024 sc1
    v_mfma_f32_16x16x32_bf16 v[40:43], v[224:227], v[104:107], v[40:43]
    v_mfma_f32_16x16x32_bf16 v[44:47], v[224:227], v[108:111], v[44:47]
    v_mfma_f32_16x16x32_bf16 v[48:51], v[224:227], v[112:115], v[48:51]
    v_mfma_f32_16x16x32_bf16 v[52:55], v[224:227], v[116:119], v[52:55]
    buffer_load_dwordx4 v[96:99], v4, s[44:47], s70 offen offset:2048 sc1
    v_mfma_f32_16x16x32_bf16 v[56:59], v[228:231], v[104:107], v[56:59]
    v_mfma_f32_16x16x32_bf16 v[60:63], v[228:231], v[108:111], v[60:63]
    v_mfma_f32_16x16x32_bf16 v[64:67], v[228:231], v[112:115], v[64:67]
    v_mfma_f32_16x16x32_bf16 v[68:71], v[228:231], v[116:119], v[68:71]
    buffer_load_dwordx4 v[100:103], v4, s[44:47], s70 offen offset:3072 sc1
    v_mfma_f32_16x16x32_bf16 v[72:75], v[232:235], v[104:107], v[72:75]
    v_mfma_f32_16x16x32_bf16 v[76:79], v[232:235], v[108:111], v[76:79]
    v_mfma_f32_16x16x32_bf16 v[80:83], v[232:235], v[112:115], v[80:83]
    v_mfma_f32_16x16x32_bf16 v[84:87], v[232:235], v[116:119], v[84:87]
    s_waitcnt vmcnt(6)
    v_mfma_f32_16x16x32_bf16 v[8:11], v[236:239], v[120:123], v[8:11]
    s_add_u32 s66, s82, 7
    s_sub_u32 s70, s66, s64
    v_mfma_f32_16x16x32_bf16 v[12:15], v[236:239], v[124:127], v[12:15]
    s_cmp_ge_u32 s66, s64
    s_cselect_b32 s66, s70, s66
    v_mfma_f32_16x16x32_bf16 v[16:19], v[236:239], v[128:131], v[16:19]
    s_lshl_b32 s70, s66, 12
    s_add_u32 s70, s70, s80
    v_mfma_f32_16x16x32_bf16 v[20:23], v[236:239], v[132:135], v[20:23]
    buffer_load_dwordx4 v[104:107], v4, s[44:47], s70 offen offset:0 sc1
    v_mfma_f32_16x16x32_bf16 v[24:27], v[240:243], v[120:123], v[24:27]
    v_mfma_f32_16x16x32_bf16 v[28:31], v[240:243], v[124:127], v[28:31]
    v_mfma_f32_16x16x32_bf16 v[32:35], v[240:243], v[128:131], v[32:35]
    v_mfma_f32_16x16x32_bf16 v[36:39], v[240:243], v[132:135], v[36:39]
    buffer_load_dwordx4 v[108:111], v4, s[44:47], s70 offen offset:1024 sc1
    v_mfma_f32_16x16x32_bf16 v[40:43], v[244:247], v[120:123], v[40:43]
    v_mfma_f32_16x16x32_bf16 v[44:47], v[244:247], v[124:127], v[44:47]
    v_mfma_f32_16x16x32_bf16 v[48:51], v[244:247], v[128:131], v[48:51]
    v_mfma_f32_16x16x32_bf16 v[52:55], v[244:247], v[132:135], v[52:55]
    buffer_load_dwordx4 v[112:115], v4, s[44:47], s70 offen offset:2048 sc1
    v_mfma_f32_16x16x32_bf16 v[56:59], v[248:251], v[120:123], v[56:59]
    v_mfma_f32_16x16x32_bf16 v[60:63], v[248:251], v[124:127], v[60:63]
    v_mfma_f32_16x16x32_bf16 v[64:67], v[248:251], v[128:131], v[64:67]
    v_mfma_f32_16x16x32_bf16 v[68:71], v[248:251], v[132:135], v[68:71]
    buffer_load_dwordx4 v[116:119], v4, s[44:47], s70 offen offset:3072 sc1
    v_mfma_f32_16x16x32_bf16 v[72:75], v[252:255], v[120:123], v[72:75]
    v_mfma_f32_16x16x32_bf16 v[76:79], v[252:255], v[124:127], v[76:79]
    v_mfma_f32_16x16x32_bf16 v[80:83], v[252:255], v[128:131], v[80:83]
    v_mfma_f32_16x16x32_bf16 v[84:87], v[252:255], v[132:135], v[84:87]
    s_waitcnt vmcnt(4)
    v_mfma_f32_16x16x32_bf16 v[8:11], v[136:139], v[88:91], v[8:11]
    s_add_u32 s66, s82, 8
    s_sub_u32 s70, s66, s64
    v_mfma_f32_16x16x32_bf16 v[12:15], v[136:139], v[92:95], v[12:15]
    s_cmp_ge_u32 s66, s64
    s_cselect_b32 s66, s70, s66
    v_mfma_f32_16x16x32_bf16 v[16:19], v[136:139], v[96:99], v[16:19]
    s_lshl_b32 s70, s66, 12
    s_add_u32 s70, s70, s80
    v_mfma_f32_16x16x32_bf16 v[20:23], v[136:139], v[100:103], v[20:23]
    buffer_load_dwordx4 v[120:123], v4, s[44:47], s70 offen offset:0 sc1
    v_mfma_f32_16x16x32_bf16 v[24:27], v[140:143], v[88:91], v[24:27]
    v_mfma_f32_16x16x32_bf16 v[28:31], v[140:143], v[92:95], v[28:31]
    v_mfma_f32_16x16x32_bf16 v[32:35], v[140:143], v[96:99], v[32:35]
    v_mfma_f32_16x16x32_bf16 v[36:39], v[140:143], v[100:103], v[36:39]
    buffer_load_dwordx4 v[124:127], v4, s[44:47], s70 offen offset:1024 sc1
    v_mfma_f32_16x16x32_bf16 v[40:43], v[144:147], v[88:91], v[40:43]
    v_mfma_f32_16x16x32_bf16 v[44:47], v[144:147], v[92:95], v[44:47]
    v_mfma_f32_16x16x32_bf16 v[48:51], v[144:147], v[96:99], v[48:51]
    v_mfma_f32_16x16x32_bf16 v[52:55], v[144:147], v[100:103], v[52:55]
    buffer_load_dwordx4 v[128:131], v4, s[44:47], s70 offen offset:2048 sc1
    v_mfma_f32_16x16x32_bf16 v[56:59], v[148:151], v[88:91], v[56:59]
    v_mfma_f32_16x16x32_bf16 v[60:63], v[148:151], v[92:95], v[60:63]
    v_mfma_f32_16x16x32_bf16 v[64:67], v[148:151], v[96:99], v[64:67]
    v_mfma_f32_16x16x32_bf16 v[68:71], v[148:151], v[100:103], v[68:71]
    buffer_load_dwordx4 v[132:135], v4, s[44:47], s70 offen offset:3072 sc1
    v_mfma_f32_16x16x32_bf16 v[72:75], v[152:155], v[88:91], v[72:75]
    v_mfma_f32_16x16x32_bf16 v[76:79], v[152:155], v[92:95], v[76:79]
    v_mfma_f32_16x16x32_bf16 v[80:83], v[152:155], v[96:99], v[80:83]
    v_mfma_f32_16x16x32_bf16 v[84:87], v[152:155], v[100:103], v[84:87]
    s_waitcnt vmcnt(4)
    v_mfma_f32_16x16x32_bf16 v[8:11], v[156:159], v[104:107], v[8:11]
    s_add_u32 s66, s82, 9
    s_sub_u32 s70, s66, s64
    v_mfma_f32_16x16x32_bf16 v[12:15], v[156:159], v[108:111], v[12:15]
    s_cmp_ge_u32 s66, s64
    s_cselect_b32 s66, s70, s66
    v_mfma_f32_16x16x32_bf16 v[16:19], v[156:159], v[112:115], v[16:19]
    s_lshl_b32 s70, s66, 12
    s_add_u32 s70, s70, s80
    v_mfma_f32_16x16x32_bf16 v[20:23], v[156:159], v[116:119], v[20:23]
    buffer_load_dwordx4 v[88:91], v5, s[44:47], s70 offen offset:0 sc1
    v_mfma_f32_16x16x32_bf16 v[24:27], v[160:163], v[104:107], v[24:27]
    v_mfma_f32_16x16x32_bf16 v[28:31], v[160:163], v[108:111], v[28:31]
    v_mfma_f32_16x16x32_bf16 v[32:35], v[160:163], v[112:115], v[32:35]
    v_mfma_f32_16x16x32_bf16 v[36:39], v[160:163], v[116:119], v[36:39]
    buffer_load_dwordx4 v[92:95], v5, s[44:47], s70 offen offset:1024 sc1
    v_mfma_f32_16x16x32_bf16 v[40:43], v[164:167], v[104:107], v[40:43]
    v_mfma_f32_16x16x32_bf16 v[44:47], v[164:167], v[108:111], v[44:47]
    v_mfma_f32_16x16x32_bf16 v[48:51], v[164:167], v[112:115], v[48:51]
    v_mfma_f32_16x16x32_bf16 v[52:55], v[164:167], v[116:119], v[52:55]
    buffer_load_dwordx4 v[96:99], v5, s[44:47], s70 offen offset:2048 sc1
    v_mfma_f32_16x16x32_bf16 v[56:59], v[168:171], v[104:107], v[56:59]
    v_mfma_f32_16x16x32_bf16 v[60:63], v[168:171], v[108:111], v[60:63]
    v_mfma_f32_16x16x32_bf16 v[64:67], v[168:171], v[112:115], v[64:67]
    v_mfma_f32_16x16x32_bf16 v[68:71], v[168:171], v[116:119], v[68:71]
    buffer_load_dwordx4 v[100:103], v5, s[44:47], s70 offen offset:3072 sc1
    v_mfma_f32_16x16x32_bf16 v[72:75], v[172:175], v[104:107], v[72:75]
    v_mfma_f32_16x16x32_bf16 v[76:79], v[172:175], v[108:111], v[76:79]
    v_mfma_f32_16x16x32_bf16 v[80:83], v[172:175], v[112:115], v[80:83]
    v_mfma_f32_16x16x32_bf16 v[84:87], v[172:175], v[116:119], v[84:87]
    s_waitcnt vmcnt(4)
    v_mfma_f32_16x16x32_bf16 v[8:11], v[176:179], v[120:123], v[8:11]
    v_mfma_f32_16x16x32_bf16 v[12:15], v[176:179], v[124:127], v[12:15]
    v_mfma_f32_16x16x32_bf16 v[16:19], v[176:179], v[128:131], v[16:19]
    v_mfma_f32_16x16x32_bf16 v[20:23], v[176:179], v[132:135], v[20:23]
    v_mfma_f32_16x16x32_bf16 v[24:27], v[180:183], v[120:123], v[24:27]
    v_mfma_f32_16x16x32_bf16 v[28:31], v[180:183], v[124:127], v[28:31]
    v_mfma_f32_16x16x32_bf16 v[32:35], v[180:183], v[128:131], v[32:35]
    v_mfma_f32_16x16x32_bf16 v[36:39], v[180:183], v[132:135], v[36:39]
    v_mfma_f32_16x16x32_bf16 v[40:43], v[184:187], v[120:123], v[40:43]
    v_mfma_f32_16x16x32_bf16 v[44:47], v[184:187], v[124:127], v[44:47]
    v_mfma_f32_16x16x32_bf16 v[48:51], v[184:187], v[128:131], v[48:51]
    v_mfma_f32_16x16x32_bf16 v[52:55], v[184:187], v[132:135], v[52:55]
    v_mfma_f32_16x16x32_bf16 v[56:59], v[188:191], v[120:123], v[56:59]
    v_mfma_f32_16x16x32_bf16 v[60:63], v[188:191], v[124:127], v[60:63]
    v_mfma_f32_16x16x32_bf16 v[64:67], v[188:191], v[128:131], v[64:67]
    v_mfma_f32_16x16x32_bf16 v[68:71], v[188:191], v[132:135], v[68:71]
    v_mfma_f32_16x16x32_bf16 v[72:75], v[192:195], v[120:123], v[72:75]
    v_mfma_f32_16x16x32_bf16 v[76:79], v[192:195], v[124:127], v[76:79]
    v_mfma_f32_16x16x32_bf16 v[80:83], v[192:195], v[128:131], v[80:83]
    v_mfma_f32_16x16x32_bf16 v[84:87], v[192:195], v[132:135], v[84:87]
    s_waitcnt vmcnt(0)
    s_cmp_eq_u32 s64, 9
    s_cbranch_scc1 L_p3_main_done
    v_mfma_f32_16x16x32_bf16 v[8:11], v[196:199], v[88:91], v[8:11]
    v_mfma_f32_16x16x32_bf16 v[12:15], v[196:199], v[92:95], v[12:15]
    v_mfma_f32_16x16x32_bf16 v[16:19], v[196:199], v[96:99], v[16:19]
    v_mfma_f32_16x16x32_bf16 v[20:23], v[196:199], v[100:103], v[20:23]
    v_mfma_f32_16x16x32_bf16 v[24:27], v[200:203], v[88:91], v[24:27]
    v_mfma_f32_16x16x32_bf16 v[28:31], v[200:203], v[92:95], v[28:31]
    v_mfma_f32_16x16x32_bf16 v[32:35], v[200:203], v[96:99], v[32:35]
    v_mfma_f32_16x16x32_bf16 v[36:39], v[200:203], v[100:103], v[36:39]
    v_mfma_f32_16x16x32_bf16 v[40:43], v[204:207], v[88:91], v[40:43]
    v_mfma_f32_16x16x32_bf16 v[44:47], v[204:207], v[92:95], v[44:47]
    v_mfma_f32_16x16x32_bf16 v[48:51], v[204:207], v[96:99], v[48:51]
    v_mfma_f32_16x16x32_bf16 v[52:55], v[204:207], v[100:103], v[52:55]
    v_mfma_f32_16x16x32_bf16 v[56:59], v[208:211], v[88:91], v[56:59]
    v_mfma_f32_16x16x32_bf16 v[60:63], v[208:211], v[92:95], v[60:63]
    v_mfma_f32_16x16x32_bf16 v[64:67], v[208:211], v[96:99], v[64:67]
    v_mfma_f32_16x16x32_bf16 v[68:71], v[208:211], v[100:103], v[68:71]
    v_mfma_f32_16x16x32_bf16 v[72:75], v[212:215], v[88:91], v[72:75]
    v_mfma_f32_16x16x32_bf16 v[76:79], v[212:215], v[92:95], v[76:79]
    v_mfma_f32_16x16x32_bf16 v[80:83], v[212:215], v[96:99], v[80:83]
    v_mfma_f32_16x16x32_bf16 v[84:87], v[212:215], v[100:103], v[84:87]
L_p3_main_done:
    s_setprio 0
    s_mov_b32 s48, s26
    s_and_b32 s49, s27, 0xffff
    s_mov_b32 s50, 2621440
    s_mov_b32 s51, 0x20000
    s_mov_b32 s52, s22
    s_and_b32 s53, s23, 0xffff
    s_mov_b32 s54, 1280
    s_mov_b32 s55, 0x20000
    s_waitcnt vmcnt(0)
    v_lshrrev_b32 v6, 4, v1
    v_lshlrev_b32 v6, 3, v6
    s_mul_i32 s60, s79, 160
    v_add_u32 v6, s60, v6
    s_add_u32 s56, s32, 0
    s_lshr_b32 s56, s56, 2
    s_lshl_b32 s56, s56, 5
    v_add_u32 v96, s56, v6
    buffer_load_dwordx2 v[88:89], v96, s[52:55], 0 offen
    s_add_u32 s56, s32, 8
    s_lshr_b32 s56, s56, 2
    s_lshl_b32 s56, s56, 5
    v_add_u32 v97, s56, v6
    buffer_load_dwordx2 v[90:91], v97, s[52:55], 0 offen
    s_add_u32 s56, s32, 16
    s_lshr_b32 s56, s56, 2
    s_lshl_b32 s56, s56, 5
    v_add_u32 v98, s56, v6
    buffer_load_dwordx2 v[92:93], v98, s[52:55], 0 offen
    s_mul_i32 s56, s32, 20480
    v_add_u32 v2, s56, v4
    s_cmp_eq_u32 s32, 0
    s_cbranch_scc0 L_t0_79
    v_lshlrev_b32 v7, 2, v1
    ds_write_b32 v7, v3
    s_branch L_red_w1
L_t0_79:
    ds_write_b128 v2, v[8:11]
L_red_w1:
    ds_write_b128 v2, v[12:15] offset:1024
    ds_write_b128 v2, v[16:19] offset:2048
    ds_write_b128 v2, v[20:23] offset:3072
    ds_write_b128 v2, v[24:27] offset:4096
    ds_write_b128 v2, v[28:31] offset:5120
    ds_write_b128 v2, v[32:35] offset:6144
    ds_write_b128 v2, v[36:39] offset:7168
    ds_write_b128 v2, v[40:43] offset:8192
    ds_write_b128 v2, v[44:47] offset:9216
    ds_write_b128 v2, v[48:51] offset:10240
    ds_write_b128 v2, v[52:55] offset:11264
    ds_write_b128 v2, v[56:59] offset:12288
    ds_write_b128 v2, v[60:63] offset:13312
    ds_write_b128 v2, v[64:67] offset:14336
    ds_write_b128 v2, v[68:71] offset:15360
    ds_write_b128 v2, v[72:75] offset:16384
    ds_write_b128 v2, v[76:79] offset:17408
    ds_write_b128 v2, v[80:83] offset:18432
    ds_write_b128 v2, v[84:87] offset:19456
    s_waitcnt lgkmcnt(0)
    s_barrier
    s_add_u32 s56, s32, 0
    s_and_b32 s58, s56, 3
    s_lshl_b32 s59, s56, 10
    v_add_u32 v2, s59, v4
    v_add_u32 v3, 0x14000, v2
    ds_read_b128 v[136:139], v2 offset:0
    ds_read_b128 v[140:143], v2 offset:20480
    ds_read_b128 v[144:147], v2 offset:40960
    ds_read_b128 v[148:151], v2 offset:61440
    ds_read_b128 v[152:155], v3 offset:0
    ds_read_b128 v[156:159], v3 offset:20480
    ds_read_b128 v[160:163], v3 offset:40960
    ds_read_b128 v[164:167], v3 offset:61440
    v_and_b32 v7, 15, v1
    s_lshl_b32 s61, s58, 4
    v_add_u32 v7, s61, v7
    v_lshlrev_b32 v100, 2, v7
    ds_read_b32 v104, v100
    s_lshl_b32 s60, s78, 6
    v_add_u32 v7, s60, v7
    v_mul_u32_u24 v7, 1280, v7
    v_add_u32 v96, v7, v96
    s_add_u32 s56, s32, 8
    s_and_b32 s58, s56, 3
    s_lshl_b32 s59, s56, 10
    v_add_u32 v2, s59, v4
    v_add_u32 v3, 0x14000, v2
    ds_read_b128 v[168:171], v2 offset:0
    ds_read_b128 v[172:175], v2 offset:20480
    ds_read_b128 v[176:179], v2 offset:40960
    ds_read_b128 v[180:183], v2 offset:61440
    ds_read_b128 v[184:187], v3 offset:0
    ds_read_b128 v[188:191], v3 offset:20480
    ds_read_b128 v[192:195], v3 offset:40960
    ds_read_b128 v[196:199], v3 offset:61440
    v_and_b32 v7, 15, v1
    s_lshl_b32 s61, s58, 4
    v_add_u32 v7, s61, v7
    v_lshlrev_b32 v101, 2, v7
    ds_read_b32 v105, v101
    s_lshl_b32 s60, s78, 6
    v_add_u32 v7, s60, v7
    v_mul_u32_u24 v7, 1280, v7
    v_add_u32 v97, v7, v97
    s_cmp_ge_u32 s32, 4
    s_cbranch_scc1 L_red_rd_done
    s_add_u32 s56, s32, 16
    s_and_b32 s58, s56, 3
    s_lshl_b32 s59, s56, 10
    v_add_u32 v2, s59, v4
    v_add_u32 v3, 0x14000, v2
    ds_read_b128 v[200:203], v2 offset:0
    ds_read_b128 v[204:207], v2 offset:20480
    ds_read_b128 v[208:211], v2 offset:40960
    ds_read_b128 v[212:215], v2 offset:61440
    ds_read_b128 v[216:219], v3 offset:0
    ds_read_b128 v[220:223], v3 offset:20480
    ds_read_b128 v[224:227], v3 offset:40960
    ds_read_b128 v[228:231], v3 offset:61440
    v_and_b32 v7, 15, v1
    s_lshl_b32 s61, s58, 4
    v_add_u32 v7, s61, v7
    v_lshlrev_b32 v102, 2, v7
    ds_read_b32 v106, v102
    s_lshl_b32 s60, s78, 6
    v_add_u32 v7, s60, v7
    v_mul_u32_u24 v7, 1280, v7
    v_add_u32 v98, v7, v98
L_red_rd_done:
    s_waitcnt vmcnt(0)
    s_cmp_ge_u32 s32, 4
    s_cbranch_scc1 L_w0_80
    s_waitcnt lgkmcnt(15)
    s_branch L_w1_81
L_w0_80:
    s_waitcnt lgkmcnt(9)
L_w1_81:
    s_cmp_eq_u32 s32, 0
    s_cbranch_scc0 L_own_82
    v_mov_b32 v136, v8
    v_mov_b32 v137, v9
    v_mov_b32 v138, v10
    v_mov_b32 v139, v11
L_own_82:
    v_pk_add_f32 v[136:137], v[136:137], v[140:141]
    v_pk_add_f32 v[144:145], v[144:145], v[148:149]
    v_pk_add_f32 v[152:153], v[152:153], v[156:157]
    v_pk_add_f32 v[160:161], v[160:161], v[164:165]
    v_pk_add_f32 v[144:145], v[144:145], v[152:153]
    v_pk_add_f32 v[144:145], v[144:145], v[160:161]
    v_pk_add_f32 v[138:139], v[138:139], v[142:143]
    v_pk_add_f32 v[146:147], v[146:147], v[150:151]
    v_pk_add_f32 v[154:155], v[154:155], v[158:159]
    v_pk_add_f32 v[162:163], v[162:163], v[166:167]
    v_pk_add_f32 v[146:147], v[146:147], v[154:155]
    v_pk_add_f32 v[146:147], v[146:147], v[162:163]
    v_lshlrev_b32 v108, 16, v88
    v_and_b32 v109, 0xffff0000, v88
    v_lshlrev_b32 v110, 16, v89
    v_and_b32 v111, 0xffff0000, v89
    v_mov_b32 v112, v104
    v_sub_f32 v114, 1.0, v104
    v_pk_add_f32 v[144:145], v[144:145], v[108:109]
    v_pk_mul_f32 v[144:145], v[144:145], v[114:115] op_sel_hi:[1,0]
    v_pk_fma_f32 v[144:145], v[136:137], v[112:113], v[144:145] op_sel_hi:[1,0,1]
    v_pk_add_f32 v[146:147], v[146:147], v[110:111]
    v_pk_mul_f32 v[146:147], v[146:147], v[114:115] op_sel_hi:[1,0]
    v_pk_fma_f32 v[146:147], v[138:139], v[112:113], v[146:147] op_sel_hi:[1,0,1]
    v_cvt_pk_bf16_f32 v136, v144, v145
    v_cvt_pk_bf16_f32 v137, v146, v147
    buffer_store_dwordx2 v[136:137], v96, s[48:51], 0 offen
    s_cmp_ge_u32 s32, 4
    s_cbranch_scc1 L_w0_83
    s_waitcnt lgkmcnt(9)
    s_branch L_w1_84
L_w0_83:
    s_waitcnt lgkmcnt(0)
L_w1_84:
    v_pk_add_f32 v[168:169], v[168:169], v[172:173]
    v_pk_add_f32 v[176:177], v[176:177], v[180:181]
    v_pk_add_f32 v[184:185], v[184:185], v[188:189]
    v_pk_add_f32 v[192:193], v[192:193], v[196:197]
    v_pk_add_f32 v[176:177], v[176:177], v[184:185]
    v_pk_add_f32 v[176:177], v[176:177], v[192:193]
    v_pk_add_f32 v[170:171], v[170:171], v[174:175]
    v_pk_add_f32 v[178:179], v[178:179], v[182:183]
    v_pk_add_f32 v[186:187], v[186:187], v[190:191]
    v_pk_add_f32 v[194:195], v[194:195], v[198:199]
    v_pk_add_f32 v[178:179], v[178:179], v[186:187]
    v_pk_add_f32 v[178:179], v[178:179], v[194:195]
    v_lshlrev_b32 v108, 16, v90
    v_and_b32 v109, 0xffff0000, v90
    v_lshlrev_b32 v110, 16, v91
    v_and_b32 v111, 0xffff0000, v91
    v_mov_b32 v112, v105
    v_sub_f32 v114, 1.0, v105
    v_pk_add_f32 v[176:177], v[176:177], v[108:109]
    v_pk_mul_f32 v[176:177], v[176:177], v[114:115] op_sel_hi:[1,0]
    v_pk_fma_f32 v[176:177], v[168:169], v[112:113], v[176:177] op_sel_hi:[1,0,1]
    v_pk_add_f32 v[178:179], v[178:179], v[110:111]
    v_pk_mul_f32 v[178:179], v[178:179], v[114:115] op_sel_hi:[1,0]
    v_pk_fma_f32 v[178:179], v[170:171], v[112:113], v[178:179] op_sel_hi:[1,0,1]
    v_cvt_pk_bf16_f32 v168, v176, v177
    v_cvt_pk_bf16_f32 v169, v178, v179
    buffer_store_dwordx2 v[168:169], v97, s[48:51], 0 offen
    s_cmp_ge_u32 s32, 4
    s_cbranch_scc1 L_fin
    s_waitcnt lgkmcnt(0)
    v_pk_add_f32 v[200:201], v[200:201], v[204:205]
    v_pk_add_f32 v[208:209], v[208:209], v[212:213]
    v_pk_add_f32 v[216:217], v[216:217], v[220:221]
    v_pk_add_f32 v[224:225], v[224:225], v[228:229]
    v_pk_add_f32 v[208:209], v[208:209], v[216:217]
    v_pk_add_f32 v[208:209], v[208:209], v[224:225]
    v_pk_add_f32 v[202:203], v[202:203], v[206:207]
    v_pk_add_f32 v[210:211], v[210:211], v[214:215]
    v_pk_add_f32 v[218:219], v[218:219], v[222:223]
    v_pk_add_f32 v[226:227], v[226:227], v[230:231]
    v_pk_add_f32 v[210:211], v[210:211], v[218:219]
    v_pk_add_f32 v[210:211], v[210:211], v[226:227]
    v_lshlrev_b32 v108, 16, v92
    v_and_b32 v109, 0xffff0000, v92
    v_lshlrev_b32 v110, 16, v93
    v_and_b32 v111, 0xffff0000, v93
    v_mov_b32 v112, v106
    v_sub_f32 v114, 1.0, v106
    v_pk_add_f32 v[208:209], v[208:209], v[108:109]
    v_pk_mul_f32 v[208:209], v[208:209], v[114:115] op_sel_hi:[1,0]
    v_pk_fma_f32 v[208:209], v[200:201], v[112:113], v[208:209] op_sel_hi:[1,0,1]
    v_pk_add_f32 v[210:211], v[210:211], v[110:111]
    v_pk_mul_f32 v[210:211], v[210:211], v[114:115] op_sel_hi:[1,0]
    v_pk_fma_f32 v[210:211], v[202:203], v[112:113], v[210:211] op_sel_hi:[1,0,1]
    v_cvt_pk_bf16_f32 v200, v208, v209
    v_cvt_pk_bf16_f32 v201, v210, v211
    buffer_store_dwordx2 v[200:201], v98, s[48:51], 0 offen
L_fin:
L_end:
    s_endpgm
.section .rodata,"a"
.p2align 6
.amdhsa_kernel gated_mix__sliding_local_dilated__dense_activation_squared_relu__prompt_kernel
  .amdhsa_next_free_vgpr 256
  .amdhsa_next_free_sgpr 102
  .amdhsa_accum_offset 256
  .amdhsa_group_segment_fixed_size 0
  .amdhsa_kernarg_size 96
  .amdhsa_user_sgpr_count 2
  .amdhsa_user_sgpr_kernarg_segment_ptr 1
  .amdhsa_system_sgpr_workgroup_id_x 1
.end_amdhsa_kernel
```
